```python
import torch

def _softmax(x, axis=-1):
    return torch.softmax(x, dim=axis)
def _gelu(x):
    return torch.nn.functional.gelu(x, approximate="tanh")
def _silu(x):
    return torch.nn.functional.silu(x)
def _sigmoid(x):
    return torch.sigmoid(x)
def _layernorm(x, axis=-1, eps=1e-5):
    m = x.mean(dim=axis, keepdim=True)
    v = x.var(dim=axis, keepdim=True, unbiased=False)
    return (x - m) / torch.sqrt(v + eps)
def _scatter_add(tgt, idx, src, axis=0):
    return tgt.clone().index_add_(axis, idx, src)
def _segment_sum(src, seg, n):
    out = torch.zeros((n,) + src.shape[1:], dtype=src.dtype)
    return out.index_add_(0, seg, src)
def _pad(x, pw):
    flat = tuple(v for pair in reversed(pw) for v in pair)
    return torch.nn.functional.pad(x, flat)

kernel_name = 'recurrent_scan__sliding_block_cached__geglu_ffn__decode'

def setup_inputs():

    _w = (lambda a: (lambda t: t.to(torch.bfloat16) if t.is_floating_point() else t)(torch.as_tensor(a)))
    def _A_setup():
        B, Sq, D = 2, 1, 640
        Hq, Hkv, Sk, Dh = 32, 32, 8192, 128
        assert Hq % Hkv == 0, (Hq, Hkv)
        return {
            "x": _w((lambda *s: torch.randn(*s, dtype=torch.bfloat16) * 0.05)(B, Sq, D)),
            "k_cache": _w((lambda *s: torch.randn(*s, dtype=torch.bfloat16) * 0.8)(B, Hkv, Sk, Dh)),
            "v_cache": _w((lambda *s: torch.randn(*s, dtype=torch.bfloat16) * 0.2)(B, Hkv, Sk, Dh)),
            "wq": _w((lambda *s: torch.randn(*s, dtype=torch.bfloat16) * 0.8)(D, Hq * Dh) * (D ** -0.5)),
            "wo": _w((lambda *s: torch.randn(*s, dtype=torch.bfloat16) * 0.2)(Hq * Dh, D) * ((Hq * Dh) ** -0.5)),
        }
    _A_in = _A_setup()

    def _B_setup():
        B, S, D, F = 2, 1, 640, 1728
        return {
            "x": _w((lambda *s: torch.randn(*s, dtype=torch.bfloat16) * 0.05)(B, S, D)),
            "w_gate": _w((lambda *s: torch.randn(*s, dtype=torch.bfloat16) * 0.1)(D, F)),
            "w_up": _w((lambda *s: torch.randn(*s, dtype=torch.bfloat16) * 0.1)(D, F)),
            "w_down": _w((lambda *s: torch.randn(*s, dtype=torch.bfloat16) * 0.1)(F, D)),
        }
    _B_in = _B_setup()

    return {
        "A_x": _A_in["x"],
        "A_k_cache": _A_in["k_cache"],
        "A_v_cache": _A_in["v_cache"],
        "A_wq": _A_in["wq"],
        "A_wo": _A_in["wo"],
        "B_x": _B_in["x"],
        "B_w_gate": _B_in["w_gate"],
        "B_w_up": _B_in["w_up"],
        "B_w_down": _B_in["w_down"],
    }

def reference(A_x, A_k_cache, A_v_cache, A_wq, A_wo, B_x, B_w_gate, B_w_up, B_w_down):
    def _A_ref(x, k_cache, v_cache, wq, wo):
        B, Sq, D = x.shape
        Hq, Dh = 32, 128
        Hkv, Sk = k_cache.shape[1], k_cache.shape[2]
        W = min(4096, max(256, Sk // 4))
        rep = Hq // Hkv
        q = (lambda x, *d: x.permute(*d))((x @ wq).reshape(B, Sq, Hq, Dh), 0, 2, 1, 3)
        k = (lambda x, n, axis: torch.repeat_interleave(x, n, dim=axis))(k_cache[:, :, Sk - W:, :], rep, axis=1)
        v = (lambda x, n, axis: torch.repeat_interleave(x, n, dim=axis))(v_cache[:, :, Sk - W:, :], rep, axis=1)
        scores = torch.einsum("bhqd,bhkd->bhqk", q, k) * (Dh ** -0.5)
        p = _softmax(scores, axis=-1)
        o = torch.einsum("bhqk,bhkd->bhqd", p, v)
        return (lambda x, *d: x.permute(*d))(o, 0, 2, 1, 3).reshape(B, Sq, Hq * Dh) @ wo

    def _B_ref(x, w_gate, w_up, w_down):
        return (_gelu(x @ w_gate) * (x @ w_up)) @ w_down

    x = A_x
    xn = _layernorm(x, axis=-1)
    s = _A_ref(xn, A_k_cache, A_v_cache, A_wq, A_wo)
    g = _silu(_B_ref(xn, B_w_gate, B_w_up, B_w_down))
    return x + s * g
```

```asm
; @launch grid=(256,1,1) block=(768,1,1) lds=15360
.amdgcn_target "amdgcn-amd-amdhsa--gfx950"
.text
.globl recurrent_scan__sliding_block_cached__geglu_ffn__decode_kernel
.p2align 8
.type recurrent_scan__sliding_block_cached__geglu_ffn__decode_kernel,@function
recurrent_scan__sliding_block_cached__geglu_ffn__decode_kernel:
    s_load_dwordx16 s[8:23], s[0:1], 0
    s_load_dwordx8 s[24:31], s[0:1], 64
    s_cmp_ge_u32 s2, 256
    s_cbranch_scc1 L_END
    s_getpc_b64 s[50:51]
L_PCREF:
    v_lshlrev_b32 v1, 4, v0
    s_sub_u32 s50, s50, L_PCREF-recurrent_scan__sliding_block_cached__geglu_ffn__decode_kernel
    s_subb_u32 s51, s51, 0
    global_load_dwordx4 v[96:99], v1, s[50:51]
    v_lshrrev_b32 v2, 6, v0
    v_and_b32 v0, 63, v0
    v_readfirstlane_b32 s3, v2
    s_lshr_b32 s4, s2, 3
    s_add_u32 s5, s4, s2
    s_and_b32 s5, s5, 7
    s_mov_b32 s98, s5
    v_and_b32 v1, 15, v0
    v_lshrrev_b32 v2, 4, v0
    s_cmp_lt_u32 s3, 4
    s_cbranch_scc1 L_SVC_DISPATCH
    s_sub_u32 s6, s3, 4
    s_lshr_b32 s44, s5, 2
    s_lshl_b32 s44, s44, 5
    s_add_u32 s44, s44, s4
    s_lshl_b32 s44, s44, 21
    s_and_b32 s45, s5, 3
    s_lshl_b32 s45, s45, 17
    s_add_u32 s44, s44, s45
    s_lshl_b32 s45, s6, 12
    s_add_u32 s44, s44, s45
    s_add_u32 s44, s44, 0x180000
    v_lshlrev_b32 v3, 4, v0
    s_mov_b32 s38, 0x8000000
    s_mov_b32 s39, 0x20000
    s_waitcnt lgkmcnt(0)
    s_mov_b32 s36, s10
    s_and_b32 s37, s11, 0xffff
    s_barrier
    s_branch L_ST_REST
L_SVC_DISPATCH:
    s_setprio 3
    s_waitcnt lgkmcnt(0)
    s_mov_b32 s32, s30
    s_and_b32 s33, s31, 0xffff
    s_mov_b32 s34, 1048576
    s_mov_b32 s35, 0x20000
    s_cmp_lt_u32 s3, 2
    s_cbranch_scc0 L_SVC_123
L_SW0:
    s_and_b32 s46, s5, 3
    s_lshl_b32 s46, s46, 1
    s_add_u32 s46, s46, s3
    s_mul_i32 s44, s46, 160
    s_mov_b32 s36, s8
    s_and_b32 s37, s9, 0xffff
    s_mov_b32 s38, 2560
    s_mov_b32 s39, 0x20000
    v_lshrrev_b32 v3, 5, v0
    v_mul_u32_u24 v3, 1280, v3
    v_and_b32 v4, 31, v0
    v_mul_u32_u24 v4, 40, v4
    v_add_u32 v3, v3, v4
    buffer_load_dwordx2 v[20:21], v3, s[36:39], 0 offen offset:0
    buffer_load_dwordx2 v[22:23], v3, s[36:39], 0 offen offset:8
    buffer_load_dwordx2 v[24:25], v3, s[36:39], 0 offen offset:16
    buffer_load_dwordx2 v[26:27], v3, s[36:39], 0 offen offset:24
    buffer_load_dwordx2 v[28:29], v3, s[36:39], 0 offen offset:32
    v_bfe_u32 v4, v0, 3, 1
    v_mul_u32_u24 v5, 1280, v4
    v_mul_u32_u24 v6, 40, v2
    v_add_u32 v5, v5, v6
    buffer_load_dwordx2 v[30:31], v5, s[36:39], s44 offen offset:0
    buffer_load_dwordx2 v[32:33], v5, s[36:39], s44 offen offset:8
    buffer_load_dwordx2 v[34:35], v5, s[36:39], s44 offen offset:16
    buffer_load_dwordx2 v[36:37], v5, s[36:39], s44 offen offset:24
    buffer_load_dwordx2 v[38:39], v5, s[36:39], s44 offen offset:32
    s_cmp_lt_u32 s4, 14
    s_cselect_b32 s40, s20, s22
    s_cselect_b32 s41, s21, s23
    s_cselect_b32 s49, 0, 14
    s_sub_u32 s49, s4, s49
    s_cmp_lt_u32 s4, 28
    s_cselect_b32 s42, 2211840, 0
    s_cmp_eq_u32 s49, 13
    s_cselect_b32 s51, 8, 16
    s_mov_b32 s45, 3456
    s_cmp_lt_u32 s5, 4
    s_cselect_b32 s40, s14, s40
    s_cselect_b32 s41, s15, s41
    s_cselect_b32 s42, 5242880, s42
    s_cselect_b32 s49, s4, s49
    s_cselect_b32 s51, 16, s51
    s_cselect_b32 s45, 8192, s45
    s_and_b32 s41, s41, 0xffff
    s_mov_b32 s43, 0x20000
    s_mul_i32 s52, s46, 80
    s_mul_i32 s52, s52, s45
    s_lshl_b32 s50, s49, 8
    s_add_u32 s52, s52, s50
    s_mul_i32 s50, s45, 20
    v_mul_lo_u32 v6, v2, s50
    v_lshl_add_u32 v6, v1, 4, v6
    v_mov_b32 v7, 0x7ffffff0
    v_cmp_gt_u32 vcc, s51, v1
    s_nop 1
    v_cndmask_b32 v6, v7, v6, vcc
    buffer_load_dwordx4 a[0:3], v6, s[40:43], s52 offen nt
    s_add_u32 s52, s52, s45
    buffer_load_dwordx4 a[4:7], v6, s[40:43], s52 offen nt
    s_add_u32 s52, s52, s45
    buffer_load_dwordx4 a[8:11], v6, s[40:43], s52 offen nt
    s_add_u32 s52, s52, s45
    buffer_load_dwordx4 a[12:15], v6, s[40:43], s52 offen nt
    s_add_u32 s52, s52, s45
    buffer_load_dwordx4 a[16:19], v6, s[40:43], s52 offen nt
    s_add_u32 s52, s52, s45
    buffer_load_dwordx4 a[20:23], v6, s[40:43], s52 offen nt
    s_add_u32 s52, s52, s45
    buffer_load_dwordx4 a[24:27], v6, s[40:43], s52 offen nt
    s_add_u32 s52, s52, s45
    buffer_load_dwordx4 a[28:31], v6, s[40:43], s52 offen nt
    s_add_u32 s52, s52, s45
    buffer_load_dwordx4 a[32:35], v6, s[40:43], s52 offen nt
    s_add_u32 s52, s52, s45
    buffer_load_dwordx4 a[36:39], v6, s[40:43], s52 offen nt
    s_add_u32 s52, s52, s45
    buffer_load_dwordx4 a[40:43], v6, s[40:43], s52 offen nt
    s_add_u32 s52, s52, s45
    buffer_load_dwordx4 a[44:47], v6, s[40:43], s52 offen nt
    s_add_u32 s52, s52, s45
    buffer_load_dwordx4 a[48:51], v6, s[40:43], s52 offen nt
    s_add_u32 s52, s52, s45
    buffer_load_dwordx4 a[52:55], v6, s[40:43], s52 offen nt
    s_add_u32 s52, s52, s45
    buffer_load_dwordx4 a[56:59], v6, s[40:43], s52 offen nt
    s_add_u32 s52, s52, s45
    buffer_load_dwordx4 a[60:63], v6, s[40:43], s52 offen nt
    s_add_u32 s52, s52, s45
    buffer_load_dwordx4 a[64:67], v6, s[40:43], s52 offen nt
    s_add_u32 s52, s52, s45
    buffer_load_dwordx4 v[88:91], v6, s[40:43], s52 offen nt
    s_add_u32 s52, s52, s45
    buffer_load_dwordx4 v[92:95], v6, s[40:43], s52 offen nt
    s_add_u32 s52, s52, s45
    buffer_load_dwordx4 v[96:99], v6, s[40:43], s52 offen nt
    s_barrier
    s_branch L_SW0_POST
L_SVC_123:
    s_cmp_eq_u32 s3, 3
    s_cbranch_scc1 L_SW3
    v_mov_b32 v60, 0
    v_mov_b32 v61, 0
    v_mov_b32 v62, 0
    v_mov_b32 v63, 0
    v_mov_b32 v12, 256
    ds_write_b128 v12, v[60:63]
    ds_write_b128 v12, v[60:63] offset:16
    s_cmp_eq_u32 s2, 0
    s_cbranch_scc0 L_NOINIT
    v_lshlrev_b32 v7, 4, v0
    s_mov_b32 s44, 917504
    buffer_store_dwordx4 v[60:63], v7, s[32:35], s44 offen sc1
    buffer_store_dwordx4 v[60:63], v7, s[32:35], s44 offen offset:1024 sc1
    buffer_store_dwordx4 v[60:63], v7, s[32:35], s44 offen offset:2048 sc1
    buffer_store_dwordx4 v[60:63], v7, s[32:35], s44 offen offset:3072 sc1
    s_waitcnt vmcnt(0)
    s_nop 0
    v_mov_b32 v60, 1
    v_mov_b32 v7, 0
    s_mov_b64 exec, 1
    global_store_dword v7, v60, s[28:29] sc1
    s_mov_b64 exec, -1
L_NOINIT:
    s_waitcnt lgkmcnt(0)
L_SVC_BAR:
    s_barrier
    s_branch L_SVC_GO
L_SW3:
    s_mul_i32 s6, s4, 3
    s_add_u32 s6, s6, s98
    s_sub_u32 s6, s6, 5
    s_cmp_lt_u32 s6, 90
    s_cselect_b32 s7, 2, 3
    s_cmp_lt_u32 s6, 70
    s_cselect_b32 s7, 1, s7
    s_cmp_lt_u32 s98, 5
    s_cselect_b32 s7, 0, s7
    s_mul_i32 s62, s4, 5
    s_add_u32 s62, s62, s98
    s_add_u32 s49, s6, 160
    s_cmp_eq_u32 s7, 0
    s_cselect_b32 s62, s62, s49
    s_cmp_lt_u32 s7, 2
    s_cselect_b32 s62, s62, 250
    s_lshl_b32 s62, s62, 10
    s_add_u32 s62, s62, 393216
    s_cmp_lt_u32 s4, 28
    s_cselect_b32 s61, 1, 0
    s_cmp_ge_u32 s5, 4
    s_cselect_b32 s61, s61, 0
    s_lshl_b32 s99, s4, 3
    s_add_u32 s99, s99, s5
    s_mul_i32 s96, s99, 512
    s_add_u32 s96, s96, 262144
    s_lshl_b32 s63, s4, 2
    s_and_b32 s49, s5, 3
    s_add_u32 s63, s63, s49
    s_lshl_b32 s63, s63, 10
    s_add_u32 s47, s63, 655360
    s_add_u32 s63, s63, 0
    v_mov_b32 v60, -1
    v_mov_b32 v61, -1
    v_mov_b32 v62, -1
    v_mov_b32 v63, -1
    v_lshlrev_b32 v7, 4, v0
    v_mov_b32 v64, 0x7ffffff0
    s_cmp_lt_u32 s7, 2
    s_cselect_b64 vcc, -1, 0
    v_cndmask_b32 v65, v64, v7, vcc
    s_cmp_eq_u32 s61, 1
    s_cselect_b64 vcc, -1, 0
    v_cndmask_b32 v66, v64, v7, vcc
    buffer_store_dwordx4 v[60:63], v65, s[32:35], s62 offen sc1
    buffer_store_dwordx4 v[60:63], v66, s[32:35], s63 offen sc1
    s_cmp_lt_u32 s5, 4
    s_cselect_b64 vcc, -1, 0
    v_cndmask_b32 v66, v64, v7, vcc
    buffer_store_dwordx4 v[60:63], v66, s[32:35], s47 offen sc1
    v_subrev_u32 v67, 32, v0
    v_lshlrev_b32 v67, 4, v67
    s_lshl_b32 s49, s4, 7
    s_add_u32 s49, s49, 925696
    s_sub_u32 s49, s49, s96
    v_add_u32 v67, s49, v67
    v_cmp_gt_u32 vcc, 32, v0
    s_nop 1
    v_cndmask_b32 v67, v67, v7, vcc
    s_cmp_eq_u32 s5, 0
    s_cselect_b32 exec_hi, 0xf, 0
    buffer_store_dwordx4 v[60:63], v67, s[32:35], s96 offen sc1
    s_mov_b32 exec_hi, -1
    s_barrier
    v_mov_b32 v13, 268
    v_mov_b32 v14, 1
    v_mov_b32 v7, 0
    s_mov_b64 exec, 1
    s_sleep 10
    global_load_dword v84, v7, s[28:29] sc1
    s_sleep 10
    global_load_dword v85, v7, s[28:29] sc1
    s_sleep 10
    global_load_dword v86, v7, s[28:29] sc1
    s_waitcnt vmcnt(3)
    ds_write_b32 v13, v14
    s_mov_b32 s53, 0
L_SV_INITW:
    s_waitcnt vmcnt(2)
    v_readfirstlane_b32 s54, v84
    s_nop 0
    s_cmp_lg_u32 s54, 0
    s_cbranch_scc1 L_SV_INITOK
    global_load_dword v84, v7, s[28:29] sc1
    s_waitcnt vmcnt(2)
    v_readfirstlane_b32 s54, v85
    s_nop 0
    s_cmp_lg_u32 s54, 0
    s_cbranch_scc1 L_SV_INITOK
    global_load_dword v85, v7, s[28:29] sc1
    s_waitcnt vmcnt(2)
    v_readfirstlane_b32 s54, v86
    s_nop 0
    s_cmp_lg_u32 s54, 0
    s_cbranch_scc1 L_SV_INITOK
    global_load_dword v86, v7, s[28:29] sc1
    s_add_u32 s53, s53, 1
    s_cmp_gt_u32 s53, 20000
    s_cbranch_scc0 L_SV_INITW
L_SV_INITOK:
    s_lshl_b32 s54, s4, 7
    s_lshl_b32 s55, s5, 2
    s_add_u32 s55, s55, s54
    s_add_u32 s55, s55, 917504
    buffer_store_dword v14, v7, s[32:35], s55 offen sc1
    v_mov_b32 v13, 264
    ds_write_b32 v13, v14
    s_mov_b64 exec, -1
    v_and_b32 v12, 7, v0
    v_and_b32 v13, 1, v0
    v_mov_b32 v14, 0xffff
    v_lshlrev_b32 v13, 4, v13
    v_lshlrev_b32 v14, v13, v14
    v_lshrrev_b32 v12, 1, v12
    v_cmp_eq_u32 vcc, 0, v12
    s_nop 1
    v_cndmask_b32 v8, 0, v14, vcc
    v_cmp_eq_u32 vcc, 1, v12
    s_nop 1
    v_cndmask_b32 v9, 0, v14, vcc
    v_cmp_eq_u32 vcc, 2, v12
    s_nop 1
    v_cndmask_b32 v10, 0, v14, vcc
    v_cmp_eq_u32 vcc, 3, v12
    s_nop 1
    v_cndmask_b32 v11, 0, v14, vcc
    s_branch L_SV_TAILLOAD
L_SW0_POST:
    s_mul_i32 s6, s4, 3
    s_add_u32 s6, s6, s98
    s_sub_u32 s6, s6, 5
    s_cmp_lt_u32 s6, 90
    s_cselect_b32 s7, 2, 3
    s_cmp_lt_u32 s6, 70
    s_cselect_b32 s7, 1, s7
    s_cmp_lt_u32 s98, 5
    s_cselect_b32 s7, 0, s7
    s_mul_i32 s62, s4, 5
    s_add_u32 s62, s62, s98
    s_add_u32 s49, s6, 160
    s_cmp_eq_u32 s7, 0
    s_cselect_b32 s62, s62, s49
    s_cmp_lt_u32 s7, 2
    s_cselect_b32 s62, s62, 250
    s_lshl_b32 s62, s62, 10
    s_add_u32 s62, s62, 393216
    s_cmp_lt_u32 s4, 28
    s_cselect_b32 s61, 1, 0
    s_cmp_ge_u32 s5, 4
    s_cselect_b32 s61, s61, 0
    s_lshl_b32 s99, s4, 3
    s_add_u32 s99, s99, s5
    s_mul_i32 s96, s99, 512
    s_add_u32 s96, s96, 262144
    s_lshl_b32 s63, s4, 2
    s_and_b32 s49, s5, 3
    s_add_u32 s63, s63, s49
    s_lshl_b32 s63, s63, 10
    s_add_u32 s47, s63, 655360
    s_add_u32 s63, s63, 0
    s_lshl_b32 s97, s4, 7
    s_lshl_b32 s49, s5, 3
    s_add_u32 s97, s97, s49
    s_add_u32 s97, s97, 925696
    v_and_b32 v12, 7, v0
    v_and_b32 v13, 1, v0
    v_mov_b32 v14, 0xffff
    v_lshlrev_b32 v13, 4, v13
    v_lshlrev_b32 v14, v13, v14
    v_lshrrev_b32 v12, 1, v12
    v_cmp_eq_u32 vcc, 0, v12
    s_nop 1
    v_cndmask_b32 v8, 0, v14, vcc
    v_cmp_eq_u32 vcc, 1, v12
    s_nop 1
    v_cndmask_b32 v9, 0, v14, vcc
    v_cmp_eq_u32 vcc, 2, v12
    s_nop 1
    v_cndmask_b32 v10, 0, v14, vcc
    v_cmp_eq_u32 vcc, 3, v12
    s_nop 1
    v_cndmask_b32 v11, 0, v14, vcc
    s_waitcnt vmcnt(25)
L_LN:
    v_lshlrev_b32 v60, 16, v20
    v_and_b32 v61, 0xffff0000, v20
    v_lshlrev_b32 v62, 16, v21
    v_and_b32 v63, 0xffff0000, v21
    v_lshlrev_b32 v64, 16, v22
    v_and_b32 v65, 0xffff0000, v22
    v_lshlrev_b32 v66, 16, v23
    v_and_b32 v67, 0xffff0000, v23
    v_lshlrev_b32 v68, 16, v24
    v_and_b32 v69, 0xffff0000, v24
    v_lshlrev_b32 v70, 16, v25
    v_and_b32 v71, 0xffff0000, v25
    v_lshlrev_b32 v72, 16, v26
    v_and_b32 v73, 0xffff0000, v26
    v_lshlrev_b32 v74, 16, v27
    v_and_b32 v75, 0xffff0000, v27
    v_lshlrev_b32 v76, 16, v28
    v_and_b32 v77, 0xffff0000, v28
    v_lshlrev_b32 v78, 16, v29
    v_and_b32 v79, 0xffff0000, v29
    v_add_f32 v80, v60, v61
    v_add_f32 v81, v62, v63
    v_add_f32 v80, v80, v64
    v_add_f32 v81, v81, v65
    v_add_f32 v80, v80, v66
    v_add_f32 v81, v81, v67
    v_add_f32 v80, v80, v68
    v_add_f32 v81, v81, v69
    v_add_f32 v80, v80, v70
    v_add_f32 v81, v81, v71
    v_add_f32 v80, v80, v72
    v_add_f32 v81, v81, v73
    v_add_f32 v80, v80, v74
    v_add_f32 v81, v81, v75
    v_add_f32 v80, v80, v76
    v_add_f32 v81, v81, v77
    v_add_f32 v80, v80, v78
    v_add_f32 v81, v81, v79
    v_add_f32 v80, v80, v81
    s_nop 1
    v_add_f32_dpp v80, v80, v80 row_ror:8 row_mask:0xf bank_mask:0xf
    s_nop 1
    v_add_f32_dpp v80, v80, v80 row_ror:4 row_mask:0xf bank_mask:0xf
    s_nop 1
    v_add_f32_dpp v80, v80, v80 row_ror:2 row_mask:0xf bank_mask:0xf
    s_nop 1
    v_add_f32_dpp v80, v80, v80 row_ror:1 row_mask:0xf bank_mask:0xf
    v_mov_b32 v81, v80
    s_nop 1
    v_permlane16_swap_b32 v81, v80
    v_add_f32 v80, v80, v81
    s_mov_b32 s49, 0x3acccccd
    v_mul_f32 v80, s49, v80
    v_sub_f32 v60, v60, v80
    v_sub_f32 v61, v61, v80
    v_sub_f32 v62, v62, v80
    v_sub_f32 v63, v63, v80
    v_sub_f32 v64, v64, v80
    v_sub_f32 v65, v65, v80
    v_sub_f32 v66, v66, v80
    v_sub_f32 v67, v67, v80
    v_sub_f32 v68, v68, v80
    v_sub_f32 v69, v69, v80
    v_sub_f32 v70, v70, v80
    v_sub_f32 v71, v71, v80
    v_sub_f32 v72, v72, v80
    v_sub_f32 v73, v73, v80
    v_sub_f32 v74, v74, v80
    v_sub_f32 v75, v75, v80
    v_sub_f32 v76, v76, v80
    v_sub_f32 v77, v77, v80
    v_sub_f32 v78, v78, v80
    v_sub_f32 v79, v79, v80
    v_mul_f32 v82, v60, v60
    v_mul_f32 v83, v61, v61
    v_fmac_f32 v82, v62, v62
    v_fmac_f32 v83, v63, v63
    v_fmac_f32 v82, v64, v64
    v_fmac_f32 v83, v65, v65
    v_fmac_f32 v82, v66, v66
    v_fmac_f32 v83, v67, v67
    v_fmac_f32 v82, v68, v68
    v_fmac_f32 v83, v69, v69
    v_fmac_f32 v82, v70, v70
    v_fmac_f32 v83, v71, v71
    v_fmac_f32 v82, v72, v72
    v_fmac_f32 v83, v73, v73
    v_fmac_f32 v82, v74, v74
    v_fmac_f32 v83, v75, v75
    v_fmac_f32 v82, v76, v76
    v_fmac_f32 v83, v77, v77
    v_fmac_f32 v82, v78, v78
    v_fmac_f32 v83, v79, v79
    v_add_f32 v82, v82, v83
    s_nop 1
    v_add_f32_dpp v82, v82, v82 row_ror:8 row_mask:0xf bank_mask:0xf
    s_nop 1
    v_add_f32_dpp v82, v82, v82 row_ror:4 row_mask:0xf bank_mask:0xf
    s_nop 1
    v_add_f32_dpp v82, v82, v82 row_ror:2 row_mask:0xf bank_mask:0xf
    s_nop 1
    v_add_f32_dpp v82, v82, v82 row_ror:1 row_mask:0xf bank_mask:0xf
    v_mov_b32 v83, v82
    s_nop 1
    v_permlane16_swap_b32 v83, v82
    v_add_f32 v82, v82, v83
    v_mul_f32 v82, s49, v82
    v_cvt_pk_bf16_f32 v80, v80, v82
    v_and_b32 v82, 0xffff0000, v80
    v_lshlrev_b32 v80, 16, v80
    v_add_f32 v82, 0x3727c5ac, v82
    v_cvt_pk_bf16_f32 v82, v82, v82
    v_and_b32 v82, 0xffff0000, v82
    v_sqrt_f32 v82, v82
    s_nop 0
    v_cvt_pk_bf16_f32 v82, v82, v82
    v_and_b32 v82, 0xffff0000, v82
    v_rcp_f32 v83, v82
    v_readlane_b32 s54, v80, 0
    v_readlane_b32 s55, v80, 32
    v_readlane_b32 s56, v83, 0
    v_readlane_b32 s57, v83, 32
    v_readlane_b32 s58, v82, 0
    v_readlane_b32 s59, v82, 32
    v_cmp_eq_u32 vcc, 0, v4
    v_mov_b32 v80, s55
    v_mov_b32 v81, s54
    v_cndmask_b32 v80, v80, v81, vcc
    v_mov_b32 v83, s57
    v_mov_b32 v81, s56
    v_cndmask_b32 v83, v83, v81, vcc
    v_mov_b32 v82, s59
    v_mov_b32 v81, s58
    v_cndmask_b32 v82, v82, v81, vcc
    s_waitcnt vmcnt(20)
L_NORM:
    v_lshlrev_b32 v40, 16, v30
    v_and_b32 v41, 0xffff0000, v30
    v_lshlrev_b32 v42, 16, v31
    v_and_b32 v43, 0xffff0000, v31
    v_lshlrev_b32 v44, 16, v32
    v_and_b32 v45, 0xffff0000, v32
    v_lshlrev_b32 v46, 16, v33
    v_and_b32 v47, 0xffff0000, v33
    v_lshlrev_b32 v48, 16, v34
    v_and_b32 v49, 0xffff0000, v34
    v_lshlrev_b32 v50, 16, v35
    v_and_b32 v51, 0xffff0000, v35
    v_lshlrev_b32 v52, 16, v36
    v_and_b32 v53, 0xffff0000, v36
    v_lshlrev_b32 v54, 16, v37
    v_and_b32 v55, 0xffff0000, v37
    v_lshlrev_b32 v56, 16, v38
    v_and_b32 v57, 0xffff0000, v38
    v_lshlrev_b32 v58, 16, v39
    v_and_b32 v59, 0xffff0000, v39
    v_sub_f32 v40, v40, v80
    v_sub_f32 v41, v41, v80
    v_sub_f32 v42, v42, v80
    v_sub_f32 v43, v43, v80
    v_sub_f32 v44, v44, v80
    v_sub_f32 v45, v45, v80
    v_sub_f32 v46, v46, v80
    v_sub_f32 v47, v47, v80
    v_sub_f32 v48, v48, v80
    v_sub_f32 v49, v49, v80
    v_sub_f32 v50, v50, v80
    v_sub_f32 v51, v51, v80
    v_sub_f32 v52, v52, v80
    v_sub_f32 v53, v53, v80
    v_sub_f32 v54, v54, v80
    v_sub_f32 v55, v55, v80
    v_sub_f32 v56, v56, v80
    v_sub_f32 v57, v57, v80
    v_sub_f32 v58, v58, v80
    v_sub_f32 v59, v59, v80
    v_cvt_pk_bf16_f32 v30, v40, v41
    v_cvt_pk_bf16_f32 v31, v42, v43
    v_cvt_pk_bf16_f32 v32, v44, v45
    v_cvt_pk_bf16_f32 v33, v46, v47
    v_cvt_pk_bf16_f32 v34, v48, v49
    v_cvt_pk_bf16_f32 v35, v50, v51
    v_cvt_pk_bf16_f32 v36, v52, v53
    v_cvt_pk_bf16_f32 v37, v54, v55
    v_cvt_pk_bf16_f32 v38, v56, v57
    v_cvt_pk_bf16_f32 v39, v58, v59
    v_lshlrev_b32 v40, 16, v30
    v_and_b32 v41, 0xffff0000, v30
    v_lshlrev_b32 v42, 16, v31
    v_and_b32 v43, 0xffff0000, v31
    v_lshlrev_b32 v44, 16, v32
    v_and_b32 v45, 0xffff0000, v32
    v_lshlrev_b32 v46, 16, v33
    v_and_b32 v47, 0xffff0000, v33
    v_lshlrev_b32 v48, 16, v34
    v_and_b32 v49, 0xffff0000, v34
    v_lshlrev_b32 v50, 16, v35
    v_and_b32 v51, 0xffff0000, v35
    v_lshlrev_b32 v52, 16, v36
    v_and_b32 v53, 0xffff0000, v36
    v_lshlrev_b32 v54, 16, v37
    v_and_b32 v55, 0xffff0000, v37
    v_lshlrev_b32 v56, 16, v38
    v_and_b32 v57, 0xffff0000, v38
    v_lshlrev_b32 v58, 16, v39
    v_and_b32 v59, 0xffff0000, v39
    v_mul_f32 v20, v40, v83
    v_mul_f32 v21, v41, v83
    v_mul_f32 v22, v42, v83
    v_mul_f32 v23, v43, v83
    v_mul_f32 v24, v44, v83
    v_mul_f32 v25, v45, v83
    v_mul_f32 v26, v46, v83
    v_mul_f32 v27, v47, v83
    v_mul_f32 v28, v48, v83
    v_mul_f32 v29, v49, v83
    v_fma_f32 v40, -v20, v82, v40
    v_fma_f32 v41, -v21, v82, v41
    v_fma_f32 v42, -v22, v82, v42
    v_fma_f32 v43, -v23, v82, v43
    v_fma_f32 v44, -v24, v82, v44
    v_fma_f32 v45, -v25, v82, v45
    v_fma_f32 v46, -v26, v82, v46
    v_fma_f32 v47, -v27, v82, v47
    v_fma_f32 v48, -v28, v82, v48
    v_fma_f32 v49, -v29, v82, v49
    v_fma_f32 v40, v40, v83, v20
    v_fma_f32 v41, v41, v83, v21
    v_fma_f32 v42, v42, v83, v22
    v_fma_f32 v43, v43, v83, v23
    v_fma_f32 v44, v44, v83, v24
    v_fma_f32 v45, v45, v83, v25
    v_fma_f32 v46, v46, v83, v26
    v_fma_f32 v47, v47, v83, v27
    v_fma_f32 v48, v48, v83, v28
    v_fma_f32 v49, v49, v83, v29
    v_mul_f32 v20, v50, v83
    v_mul_f32 v21, v51, v83
    v_mul_f32 v22, v52, v83
    v_mul_f32 v23, v53, v83
    v_mul_f32 v24, v54, v83
    v_mul_f32 v25, v55, v83
    v_mul_f32 v26, v56, v83
    v_mul_f32 v27, v57, v83
    v_mul_f32 v28, v58, v83
    v_mul_f32 v29, v59, v83
    v_fma_f32 v50, -v20, v82, v50
    v_fma_f32 v51, -v21, v82, v51
    v_fma_f32 v52, -v22, v82, v52
    v_fma_f32 v53, -v23, v82, v53
    v_fma_f32 v54, -v24, v82, v54
    v_fma_f32 v55, -v25, v82, v55
    v_fma_f32 v56, -v26, v82, v56
    v_fma_f32 v57, -v27, v82, v57
    v_fma_f32 v58, -v28, v82, v58
    v_fma_f32 v59, -v29, v82, v59
    v_fma_f32 v50, v50, v83, v20
    v_fma_f32 v51, v51, v83, v21
    v_fma_f32 v52, v52, v83, v22
    v_fma_f32 v53, v53, v83, v23
    v_fma_f32 v54, v54, v83, v24
    v_fma_f32 v55, v55, v83, v25
    v_fma_f32 v56, v56, v83, v26
    v_fma_f32 v57, v57, v83, v27
    v_fma_f32 v58, v58, v83, v28
    v_fma_f32 v59, v59, v83, v29
    v_cvt_pk_bf16_f32 v40, v40, v40
    v_cvt_pk_bf16_f32 v41, v41, v41
    v_cvt_pk_bf16_f32 v42, v42, v42
    v_cvt_pk_bf16_f32 v43, v43, v43
    v_cvt_pk_bf16_f32 v44, v44, v44
    v_cvt_pk_bf16_f32 v45, v45, v45
    v_cvt_pk_bf16_f32 v46, v46, v46
    v_cvt_pk_bf16_f32 v47, v47, v47
    v_cvt_pk_bf16_f32 v48, v48, v48
    v_cvt_pk_bf16_f32 v49, v49, v49
    v_cvt_pk_bf16_f32 v50, v50, v50
    v_cvt_pk_bf16_f32 v51, v51, v51
    v_cvt_pk_bf16_f32 v52, v52, v52
    v_cvt_pk_bf16_f32 v53, v53, v53
    v_cvt_pk_bf16_f32 v54, v54, v54
    v_cvt_pk_bf16_f32 v55, v55, v55
    v_cvt_pk_bf16_f32 v56, v56, v56
    v_cvt_pk_bf16_f32 v57, v57, v57
    v_cvt_pk_bf16_f32 v58, v58, v58
    v_cvt_pk_bf16_f32 v59, v59, v59
L_Q_GEMV:
    v_and_b32 v12, v40, v8
    v_and_b32 v13, v40, v9
    v_and_b32 v14, v40, v10
    v_and_b32 v15, v40, v11
    v_and_b32 v16, v41, v8
    v_and_b32 v17, v41, v9
    v_and_b32 v18, v41, v10
    v_and_b32 v19, v41, v11
    s_waitcnt vmcnt(19)
    v_mfma_f32_16x16x32_bf16 v[84:87], v[12:15], a[0:3], 0
    v_and_b32 v12, v42, v8
    v_and_b32 v13, v42, v9
    v_and_b32 v14, v42, v10
    v_and_b32 v15, v42, v11
    s_waitcnt vmcnt(18)
    v_mfma_f32_16x16x32_bf16 v[84:87], v[16:19], a[4:7], v[84:87]
    v_and_b32 v16, v43, v8
    v_and_b32 v17, v43, v9
    v_and_b32 v18, v43, v10
    v_and_b32 v19, v43, v11
    s_waitcnt vmcnt(17)
    v_mfma_f32_16x16x32_bf16 v[84:87], v[12:15], a[8:11], v[84:87]
    v_and_b32 v12, v44, v8
    v_and_b32 v13, v44, v9
    v_and_b32 v14, v44, v10
    v_and_b32 v15, v44, v11
    s_waitcnt vmcnt(16)
    v_mfma_f32_16x16x32_bf16 v[84:87], v[16:19], a[12:15], v[84:87]
    v_and_b32 v16, v45, v8
    v_and_b32 v17, v45, v9
    v_and_b32 v18, v45, v10
    v_and_b32 v19, v45, v11
    s_waitcnt vmcnt(15)
    v_mfma_f32_16x16x32_bf16 v[84:87], v[12:15], a[16:19], v[84:87]
    v_and_b32 v12, v46, v8
    v_and_b32 v13, v46, v9
    v_and_b32 v14, v46, v10
    v_and_b32 v15, v46, v11
    s_waitcnt vmcnt(14)
    v_mfma_f32_16x16x32_bf16 v[84:87], v[16:19], a[20:23], v[84:87]
    v_and_b32 v16, v47, v8
    v_and_b32 v17, v47, v9
    v_and_b32 v18, v47, v10
    v_and_b32 v19, v47, v11
    s_waitcnt vmcnt(13)
    v_mfma_f32_16x16x32_bf16 v[84:87], v[12:15], a[24:27], v[84:87]
    v_and_b32 v12, v48, v8
    v_and_b32 v13, v48, v9
    v_and_b32 v14, v48, v10
    v_and_b32 v15, v48, v11
    s_waitcnt vmcnt(12)
    v_mfma_f32_16x16x32_bf16 v[84:87], v[16:19], a[28:31], v[84:87]
    v_and_b32 v16, v49, v8
    v_and_b32 v17, v49, v9
    v_and_b32 v18, v49, v10
    v_and_b32 v19, v49, v11
    s_waitcnt vmcnt(11)
    v_mfma_f32_16x16x32_bf16 v[84:87], v[12:15], a[32:35], v[84:87]
    v_and_b32 v12, v50, v8
    v_and_b32 v13, v50, v9
    v_and_b32 v14, v50, v10
    v_and_b32 v15, v50, v11
    s_waitcnt vmcnt(10)
    v_mfma_f32_16x16x32_bf16 v[84:87], v[16:19], a[36:39], v[84:87]
    v_and_b32 v16, v51, v8
    v_and_b32 v17, v51, v9
    v_and_b32 v18, v51, v10
    v_and_b32 v19, v51, v11
    s_waitcnt vmcnt(9)
    v_mfma_f32_16x16x32_bf16 v[84:87], v[12:15], a[40:43], v[84:87]
    v_and_b32 v12, v52, v8
    v_and_b32 v13, v52, v9
    v_and_b32 v14, v52, v10
    v_and_b32 v15, v52, v11
    s_waitcnt vmcnt(8)
    v_mfma_f32_16x16x32_bf16 v[84:87], v[16:19], a[44:47], v[84:87]
    v_and_b32 v16, v53, v8
    v_and_b32 v17, v53, v9
    v_and_b32 v18, v53, v10
    v_and_b32 v19, v53, v11
    s_waitcnt vmcnt(7)
    v_mfma_f32_16x16x32_bf16 v[84:87], v[12:15], a[48:51], v[84:87]
    v_and_b32 v12, v54, v8
    v_and_b32 v13, v54, v9
    v_and_b32 v14, v54, v10
    v_and_b32 v15, v54, v11
    s_waitcnt vmcnt(6)
    v_mfma_f32_16x16x32_bf16 v[84:87], v[16:19], a[52:55], v[84:87]
    v_and_b32 v16, v55, v8
    v_and_b32 v17, v55, v9
    v_and_b32 v18, v55, v10
    v_and_b32 v19, v55, v11
    s_waitcnt vmcnt(5)
    v_mfma_f32_16x16x32_bf16 v[84:87], v[12:15], a[56:59], v[84:87]
    v_and_b32 v12, v56, v8
    v_and_b32 v13, v56, v9
    v_and_b32 v14, v56, v10
    v_and_b32 v15, v56, v11
    s_waitcnt vmcnt(4)
    v_mfma_f32_16x16x32_bf16 v[84:87], v[16:19], a[60:63], v[84:87]
    v_and_b32 v16, v57, v8
    v_and_b32 v17, v57, v9
    v_and_b32 v18, v57, v10
    v_and_b32 v19, v57, v11
    s_waitcnt vmcnt(3)
    v_mfma_f32_16x16x32_bf16 v[84:87], v[12:15], a[64:67], v[84:87]
    v_and_b32 v12, v58, v8
    v_and_b32 v13, v58, v9
    v_and_b32 v14, v58, v10
    v_and_b32 v15, v58, v11
    s_waitcnt vmcnt(2)
    v_mfma_f32_16x16x32_bf16 v[84:87], v[16:19], v[88:91], v[84:87]
    v_and_b32 v16, v59, v8
    v_and_b32 v17, v59, v9
    v_and_b32 v18, v59, v10
    v_and_b32 v19, v59, v11
    s_waitcnt vmcnt(1)
    v_mfma_f32_16x16x32_bf16 v[84:87], v[12:15], v[92:95], v[84:87]
    s_waitcnt vmcnt(0)
    v_mfma_f32_16x16x32_bf16 v[84:87], v[16:19], v[96:99], v[84:87]
    v_lshlrev_b32 v6, 4, v0
    v_mov_b32 v17, 280
    s_cmp_eq_u32 s3, 0
    s_cbranch_scc1 L_UNIT_SW0
    s_nop 3
    ds_write_b128 v6, v[84:87] offset:6144
    v_mov_b32 v18, 1
    s_waitcnt lgkmcnt(0)
    ds_write_b32 v17, v18
    s_branch L_SV_TAILLOAD
L_UNIT_SW0:
L_UNIT_W:
    ds_read_b32 v18, v17
    s_waitcnt lgkmcnt(0)
    v_readfirstlane_b32 s48, v18
    s_nop 0
    s_cmp_lg_u32 s48, 0
    s_cbranch_scc1 L_UNIT_W_OK
    s_sleep 4
    s_branch L_UNIT_W
L_UNIT_W_OK:
    ds_read_b128 v[88:91], v6 offset:6144
    s_waitcnt lgkmcnt(0)
    v_add_f32 v84, v84, v88
    v_add_f32 v85, v85, v89
    v_add_f32 v86, v86, v90
    v_add_f32 v87, v87, v91
    v_min_u32 v96, -2, v84
    v_min_u32 v97, -2, v85
    v_min_u32 v98, -2, v86
    v_min_u32 v99, -2, v87
    s_cmp_lt_u32 s5, 4
    s_cbranch_scc0 L_Q_WAITF
    v_mov_b32 v17, 268
L_SV_CLRW:
    ds_read_b32 v18, v17
    s_waitcnt lgkmcnt(0)
    v_readfirstlane_b32 s48, v18
    s_nop 0
    s_cmp_lg_u32 s48, 0
    s_cbranch_scc1 L_SV_CLRW_OK
    s_sleep 4
    s_branch L_SV_CLRW
L_SV_CLRW_OK:
    buffer_store_dwordx4 v[96:99], v6, s[32:35], s47 offen sc1
L_Q_WAITF:
    v_mov_b32 v17, 264
L_SV_INIW:
    ds_read_b32 v18, v17
    s_waitcnt lgkmcnt(0)
    v_readfirstlane_b32 s48, v18
    s_nop 0
    s_cmp_lg_u32 s48, 0
    s_cbranch_scc1 L_SV_INIW_OK
    s_sleep 4
    s_branch L_SV_INIW
L_SV_INIW_OK:
    s_lshl_b32 s54, s4, 7
    s_add_u32 s54, s54, 917504
    s_mov_b64 exec, 0xff
    v_lshlrev_b32 v61, 2, v0
    s_mov_b32 s53, 0
    buffer_load_dword v62, v61, s[32:35], s54 offen sc1
    s_sleep 8
    buffer_load_dword v63, v61, s[32:35], s54 offen sc1
    s_sleep 8
    buffer_load_dword v64, v61, s[32:35], s54 offen sc1
L_SV0_FP:
    s_waitcnt vmcnt(2)
    v_cmp_ne_u32 vcc, 1, v62
    s_cbranch_vccz L_SV0_FOK
    buffer_load_dword v62, v61, s[32:35], s54 offen sc1
    s_waitcnt vmcnt(2)
    v_cmp_ne_u32 vcc, 1, v63
    s_cbranch_vccz L_SV0_FOK
    buffer_load_dword v63, v61, s[32:35], s54 offen sc1
    s_waitcnt vmcnt(2)
    v_cmp_ne_u32 vcc, 1, v64
    s_cbranch_vccz L_SV0_FOK
    buffer_load_dword v64, v61, s[32:35], s54 offen sc1
    s_add_u32 s53, s53, 1
    s_cmp_gt_u32 s53, 20000
    s_cbranch_scc0 L_SV0_FP
L_SV0_FOK:
    s_mov_b64 exec, -1
    v_lshrrev_b32 v60, 5, v0
    v_lshlrev_b32 v60, 11, v60
    v_and_b32 v61, 31, v0
    v_lshl_add_u32 v60, v61, 4, v60
    v_and_b32 v61, 1, v2
    s_lshl_b32 s54, s4, 12
    s_lshr_b32 s55, s5, 2
    s_lshl_b32 s55, s55, 9
    s_add_u32 s54, s54, s55
    s_add_u32 s54, s54, 655360
    s_mov_b32 s53, 0
L_SV0_GP:
    buffer_load_dwordx4 v[64:67], v60, s[32:35], s54 offen offset:0 sc1
    buffer_load_dwordx4 v[68:71], v60, s[32:35], s54 offen offset:1024 sc1
    s_add_u32 s53, s53, 1
    s_waitcnt vmcnt(0)
    v_max3_u32 v80, v64, v65, v66
    v_max3_u32 v81, v67, v68, v69
    v_max3_u32 v80, v80, v70, v71
    v_max_u32 v80, v80, v81
    v_cmp_eq_u32 vcc, -1, v80
    s_cmp_gt_u32 s53, 20000
    s_cbranch_scc1 L_SV0_GOK
    s_cbranch_vccnz L_SV0_GP
L_SV0_GOK:
    v_add_f32 v64, v64, v68
    v_add_f32 v65, v65, v69
    v_add_f32 v66, v66, v70
    v_add_f32 v67, v67, v71
    v_mov_b32 v68, v64
    v_mov_b32 v69, v65
    v_mov_b32 v70, v66
    v_mov_b32 v71, v67
    v_permlane32_swap_b32 v68, v64
    v_permlane32_swap_b32 v69, v65
    v_permlane32_swap_b32 v70, v66
    v_permlane32_swap_b32 v71, v67
    v_add_f32 v64, v64, v68
    v_add_f32 v65, v65, v69
    v_add_f32 v66, v66, v70
    v_add_f32 v67, v67, v71
    v_cvt_pk_bf16_f32 v64, v64, v65
    v_cvt_pk_bf16_f32 v65, v66, v67
    v_lshlrev_b32 v60, 4, v1
    v_lshl_add_u32 v60, v61, 3, v60
    ds_write_b64 v60, v[64:65] offset:0
    v_mov_b32 v62, 256
    v_mov_b32 v63, 1
    s_waitcnt lgkmcnt(0)
    ds_write_b32 v62, v63
    s_branch L_SV_TAILLOAD
L_SVC_GO:
    v_and_b32 v12, 7, v0
    v_and_b32 v13, 1, v0
    v_mov_b32 v14, 0xffff
    v_lshlrev_b32 v13, 4, v13
    v_lshlrev_b32 v14, v13, v14
    v_lshrrev_b32 v12, 1, v12
    v_cmp_eq_u32 vcc, 0, v12
    s_nop 1
    v_cndmask_b32 v8, 0, v14, vcc
    v_cmp_eq_u32 vcc, 1, v12
    s_nop 1
    v_cndmask_b32 v9, 0, v14, vcc
    v_cmp_eq_u32 vcc, 2, v12
    s_nop 1
    v_cndmask_b32 v10, 0, v14, vcc
    v_cmp_eq_u32 vcc, 3, v12
    s_nop 1
    v_cndmask_b32 v11, 0, v14, vcc
L_SERVICE:
    s_mul_i32 s6, s4, 3
    s_add_u32 s6, s6, s98
    s_sub_u32 s6, s6, 5
    s_cmp_lt_u32 s6, 90
    s_cselect_b32 s7, 2, 3
    s_cmp_lt_u32 s6, 70
    s_cselect_b32 s7, 1, s7
    s_cmp_lt_u32 s98, 5
    s_cselect_b32 s7, 0, s7
    s_mul_i32 s62, s4, 5
    s_add_u32 s62, s62, s98
    s_add_u32 s49, s6, 160
    s_cmp_eq_u32 s7, 0
    s_cselect_b32 s62, s62, s49
    s_cmp_lt_u32 s7, 2
    s_cselect_b32 s62, s62, 250
    s_lshl_b32 s62, s62, 10
    s_add_u32 s62, s62, 393216
    s_cmp_lt_u32 s4, 28
    s_cselect_b32 s61, 1, 0
    s_cmp_ge_u32 s5, 4
    s_cselect_b32 s61, s61, 0
    s_lshl_b32 s99, s4, 3
    s_add_u32 s99, s99, s5
    s_mul_i32 s96, s99, 512
    s_add_u32 s96, s96, 262144
    s_lshl_b32 s63, s4, 2
    s_and_b32 s49, s5, 3
    s_add_u32 s63, s63, s49
    s_lshl_b32 s63, s63, 10
    s_add_u32 s47, s63, 655360
    s_add_u32 s63, s63, 0
    s_branch L_SW2
L_SW2:
L_SW2_NI:
    s_cmp_eq_u32 s7, 1
    s_cbranch_scc1 L_SW2_CHK
    s_cmp_eq_u32 s7, 2
    s_cbranch_scc0 L_SV_TAILLOAD
L_SW2_CHK:
    v_mov_b32 v17, 256
L_SW2_QW:
    ds_read_b32 v18, v17
    s_waitcnt lgkmcnt(0)
    v_readfirstlane_b32 s48, v18
    s_nop 0
    s_cmp_lg_u32 s48, 0
    s_cbranch_scc1 L_SW2_QW_OK
    s_sleep 4
    s_branch L_SW2_QW
L_SW2_QW_OK:
    v_lshrrev_b32 v60, 1, v0
    v_lshlrev_b32 v60, 7, v60
    v_and_b32 v61, 1, v0
    v_lshl_add_u32 v60, v61, 4, v60
    s_mov_b32 s54, 917504
    s_mov_b32 s53, 0
L_SW2_FP:
    buffer_load_dwordx4 v[20:23], v60, s[32:35], s54 offen sc1
    s_add_u32 s53, s53, 1
    s_waitcnt vmcnt(0)
    v_and_b32 v20, v20, v21
    v_and_b32 v22, v22, v23
    v_and_b32 v20, v20, v22
    v_cmp_ne_u32 vcc, 1, v20
    s_cmp_gt_u32 s53, 20000
    s_cbranch_scc1 L_SW2_DONE
    s_cbranch_vccz L_SW2_DONE
    s_sleep 8
    s_branch L_SW2_FP
L_SW2_DONE:
    v_mov_b32 v17, 276
    v_mov_b32 v18, 1
    ds_write_b32 v17, v18
    s_branch L_SV_TAILLOAD
L_ST_REST:
    s_add_u32 s45, s44, 0x8000
    s_add_u32 s46, s44, 0x10000
    s_add_u32 s47, s44, 0x18000
    buffer_load_dwordx4 v[36:39], v3, s[36:39], s44 offen offset:0 nt
    buffer_load_dwordx4 v[40:43], v3, s[36:39], s44 offen offset:1024 nt
    buffer_load_dwordx4 v[44:47], v3, s[36:39], s44 offen offset:2048 nt
    s_waitcnt vmcnt(2)
    buffer_load_dwordx4 v[48:51], v3, s[36:39], s44 offen offset:3072 nt
    s_mov_b32 s40, s12
    s_and_b32 s41, s13, 0xffff
    s_mov_b32 s42, 0x8000000
    s_mov_b32 s43, 0x20000
    v_and_b32 v12, 7, v0
    v_and_b32 v13, 1, v0
    v_mov_b32 v14, 0xffff
    v_lshlrev_b32 v13, 4, v13
    v_lshlrev_b32 v14, v13, v14
    v_lshrrev_b32 v12, 1, v12
    v_cmp_eq_u32 vcc, 0, v12
    s_nop 1
    v_cndmask_b32 v8, 0, v14, vcc
    v_cmp_eq_u32 vcc, 1, v12
    s_nop 1
    v_cndmask_b32 v9, 0, v14, vcc
    v_cmp_eq_u32 vcc, 2, v12
    s_nop 1
    v_cndmask_b32 v10, 0, v14, vcc
    v_cmp_eq_u32 vcc, 3, v12
    s_nop 1
    v_cndmask_b32 v11, 0, v14, vcc
    v_lshlrev_b32 v12, 4, v1
    v_mov_b32 v13, 256
    v_mov_b32 v14, 1
    s_waitcnt vmcnt(2)
    buffer_load_dwordx4 v[52:55], v3, s[36:39], s45 offen offset:0 nt
    s_waitcnt vmcnt(2)
    buffer_load_dwordx4 v[56:59], v3, s[36:39], s45 offen offset:1024 nt
    s_waitcnt vmcnt(2)
    buffer_load_dwordx4 v[60:63], v3, s[36:39], s45 offen offset:2048 nt
    s_waitcnt vmcnt(2)
    buffer_load_dwordx4 v[64:67], v3, s[36:39], s45 offen offset:3072 nt
    s_waitcnt vmcnt(2)
    buffer_load_dwordx4 v[68:71], v3, s[36:39], s46 offen offset:0 nt
    s_waitcnt vmcnt(2)
    buffer_load_dwordx4 v[72:75], v3, s[36:39], s46 offen offset:1024 nt
    s_waitcnt vmcnt(2)
    buffer_load_dwordx4 v[76:79], v3, s[36:39], s46 offen offset:2048 nt
    s_waitcnt vmcnt(2)
    buffer_load_dwordx4 v[80:83], v3, s[36:39], s46 offen offset:3072 nt
    s_waitcnt vmcnt(2)
    buffer_load_dwordx4 v[84:87], v3, s[36:39], s47 offen offset:0 nt
    s_waitcnt vmcnt(2)
    buffer_load_dwordx4 v[88:91], v3, s[36:39], s47 offen offset:1024 nt
    s_waitcnt vmcnt(2)
    buffer_load_dwordx4 v[92:95], v3, s[36:39], s47 offen offset:2048 nt
    s_waitcnt vmcnt(2)
    buffer_load_dwordx4 v[96:99], v3, s[36:39], s47 offen offset:3072 nt
    s_waitcnt vmcnt(3)
    buffer_load_dwordx4 a[0:3], v3, s[40:43], s44 offen offset:0 nt
    s_waitcnt vmcnt(3)
    buffer_load_dwordx4 a[4:7], v3, s[40:43], s44 offen offset:1024 nt
    s_waitcnt vmcnt(3)
    buffer_load_dwordx4 a[8:11], v3, s[40:43], s44 offen offset:2048 nt
    s_waitcnt vmcnt(3)
    buffer_load_dwordx4 a[12:15], v3, s[40:43], s44 offen offset:3072 nt
    s_waitcnt vmcnt(3)
    buffer_load_dwordx4 a[16:19], v3, s[40:43], s45 offen offset:0 nt
    s_waitcnt vmcnt(3)
    buffer_load_dwordx4 a[20:23], v3, s[40:43], s45 offen offset:1024 nt
    s_waitcnt vmcnt(3)
    buffer_load_dwordx4 a[24:27], v3, s[40:43], s45 offen offset:2048 nt
    s_waitcnt vmcnt(3)
    buffer_load_dwordx4 a[28:31], v3, s[40:43], s45 offen offset:3072 nt
    s_waitcnt vmcnt(3)
    buffer_load_dwordx4 a[32:35], v3, s[40:43], s46 offen offset:0 nt
    s_waitcnt vmcnt(3)
    buffer_load_dwordx4 a[36:39], v3, s[40:43], s46 offen offset:1024 nt
L_ST_QW:
    ds_read_b32 v15, v13
    s_waitcnt lgkmcnt(0)
    v_readfirstlane_b32 s48, v15
    s_nop 0
    s_cmp_lg_u32 s48, 0
    s_cbranch_scc1 L_ST_QW_OK
    s_sleep 4
    s_branch L_ST_QW
L_ST_QW_OK:
    ds_read_b128 v[4:7], v12
    s_waitcnt lgkmcnt(0)
    v_dot2_f32_bf16 v36, v36, v4, 0
    v_dot2_f32_bf16 v36, v37, v5, v36
    v_dot2_f32_bf16 v36, v38, v6, v36
    v_dot2_f32_bf16 v36, v39, v7, v36
    v_dot2_f32_bf16 v40, v40, v4, 0
    v_dot2_f32_bf16 v40, v41, v5, v40
    v_dot2_f32_bf16 v40, v42, v6, v40
    v_dot2_f32_bf16 v40, v43, v7, v40
    v_dot2_f32_bf16 v44, v44, v4, 0
    v_dot2_f32_bf16 v44, v45, v5, v44
    v_dot2_f32_bf16 v44, v46, v6, v44
    v_dot2_f32_bf16 v44, v47, v7, v44
    s_waitcnt vmcnt(3)
    buffer_load_dwordx4 a[40:43], v3, s[40:43], s46 offen offset:2048 nt
    v_dot2_f32_bf16 v48, v48, v4, 0
    v_dot2_f32_bf16 v48, v49, v5, v48
    v_dot2_f32_bf16 v48, v50, v6, v48
    v_dot2_f32_bf16 v48, v51, v7, v48
    v_dot2_f32_bf16 v52, v52, v4, 0
    v_dot2_f32_bf16 v52, v53, v5, v52
    v_dot2_f32_bf16 v52, v54, v6, v52
    v_dot2_f32_bf16 v52, v55, v7, v52
    v_dot2_f32_bf16 v56, v56, v4, 0
    v_dot2_f32_bf16 v56, v57, v5, v56
    v_dot2_f32_bf16 v56, v58, v6, v56
    v_dot2_f32_bf16 v56, v59, v7, v56
    s_waitcnt vmcnt(3)
    buffer_load_dwordx4 a[44:47], v3, s[40:43], s46 offen offset:3072 nt
    v_dot2_f32_bf16 v60, v60, v4, 0
    v_dot2_f32_bf16 v60, v61, v5, v60
    v_dot2_f32_bf16 v60, v62, v6, v60
    v_dot2_f32_bf16 v60, v63, v7, v60
    v_dot2_f32_bf16 v64, v64, v4, 0
    v_dot2_f32_bf16 v64, v65, v5, v64
    v_dot2_f32_bf16 v64, v66, v6, v64
    v_dot2_f32_bf16 v64, v67, v7, v64
    s_waitcnt vmcnt(3)
    buffer_load_dwordx4 a[48:51], v3, s[40:43], s47 offen offset:0 nt
    v_dot2_f32_bf16 v68, v68, v4, 0
    v_dot2_f32_bf16 v68, v69, v5, v68
    v_dot2_f32_bf16 v68, v70, v6, v68
    v_dot2_f32_bf16 v68, v71, v7, v68
    v_dot2_f32_bf16 v72, v72, v4, 0
    v_dot2_f32_bf16 v72, v73, v5, v72
    v_dot2_f32_bf16 v72, v74, v6, v72
    v_dot2_f32_bf16 v72, v75, v7, v72
    v_dot2_f32_bf16 v76, v76, v4, 0
    v_dot2_f32_bf16 v76, v77, v5, v76
    v_dot2_f32_bf16 v76, v78, v6, v76
    v_dot2_f32_bf16 v76, v79, v7, v76
    s_waitcnt vmcnt(3)
    buffer_load_dwordx4 a[52:55], v3, s[40:43], s47 offen offset:1024 nt
    v_dot2_f32_bf16 v80, v80, v4, 0
    v_dot2_f32_bf16 v80, v81, v5, v80
    v_dot2_f32_bf16 v80, v82, v6, v80
    v_dot2_f32_bf16 v80, v83, v7, v80
    v_dot2_f32_bf16 v84, v84, v4, 0
    v_dot2_f32_bf16 v84, v85, v5, v84
    v_dot2_f32_bf16 v84, v86, v6, v84
    v_dot2_f32_bf16 v84, v87, v7, v84
    v_dot2_f32_bf16 v88, v88, v4, 0
    v_dot2_f32_bf16 v88, v89, v5, v88
    v_dot2_f32_bf16 v88, v90, v6, v88
    v_dot2_f32_bf16 v88, v91, v7, v88
    s_waitcnt vmcnt(3)
    buffer_load_dwordx4 a[56:59], v3, s[40:43], s47 offen offset:2048 nt
    v_dot2_f32_bf16 v92, v92, v4, 0
    v_dot2_f32_bf16 v92, v93, v5, v92
    v_dot2_f32_bf16 v92, v94, v6, v92
    v_dot2_f32_bf16 v92, v95, v7, v92
    v_dot2_f32_bf16 v96, v96, v4, 0
    v_dot2_f32_bf16 v96, v97, v5, v96
    v_dot2_f32_bf16 v96, v98, v6, v96
    v_dot2_f32_bf16 v96, v99, v7, v96
    s_waitcnt vmcnt(3)
    buffer_load_dwordx4 a[60:63], v3, s[40:43], s47 offen offset:3072 nt
    s_mov_b64 exec, 1
    ds_add_u32 v13, v14 offset:4
    s_mov_b64 exec, -1
    s_nop 0
    v_add_f32_dpp v36, v36, v36 row_ror:8 row_mask:0xf bank_mask:0x3
    v_add_f32_dpp v40, v40, v40 row_ror:8 row_mask:0xf bank_mask:0x3
    v_add_f32_dpp v44, v44, v44 row_ror:8 row_mask:0xf bank_mask:0x3
    v_add_f32_dpp v48, v48, v48 row_ror:8 row_mask:0xf bank_mask:0x3
    v_add_f32_dpp v52, v52, v52 row_ror:8 row_mask:0xf bank_mask:0x3
    v_add_f32_dpp v56, v56, v56 row_ror:8 row_mask:0xf bank_mask:0x3
    v_add_f32_dpp v60, v60, v60 row_ror:8 row_mask:0xf bank_mask:0x3
    v_add_f32_dpp v64, v64, v64 row_ror:8 row_mask:0xf bank_mask:0x3
    v_add_f32_dpp v36, v68, v68 row_ror:8 row_mask:0xf bank_mask:0xc
    v_add_f32_dpp v40, v72, v72 row_ror:8 row_mask:0xf bank_mask:0xc
    v_add_f32_dpp v44, v76, v76 row_ror:8 row_mask:0xf bank_mask:0xc
    v_add_f32_dpp v48, v80, v80 row_ror:8 row_mask:0xf bank_mask:0xc
    v_add_f32_dpp v52, v84, v84 row_ror:8 row_mask:0xf bank_mask:0xc
    v_add_f32_dpp v56, v88, v88 row_ror:8 row_mask:0xf bank_mask:0xc
    v_add_f32_dpp v60, v92, v92 row_ror:8 row_mask:0xf bank_mask:0xc
    v_add_f32_dpp v64, v96, v96 row_ror:8 row_mask:0xf bank_mask:0xc
    v_add_f32_dpp v36, v36, v36 row_shl:4 row_mask:0xf bank_mask:0x5
    v_add_f32_dpp v40, v40, v40 row_shl:4 row_mask:0xf bank_mask:0x5
    v_add_f32_dpp v44, v44, v44 row_shl:4 row_mask:0xf bank_mask:0x5
    v_add_f32_dpp v48, v48, v48 row_shl:4 row_mask:0xf bank_mask:0x5
    v_add_f32_dpp v36, v52, v52 row_shr:4 row_mask:0xf bank_mask:0xa
    v_add_f32_dpp v40, v56, v56 row_shr:4 row_mask:0xf bank_mask:0xa
    v_add_f32_dpp v44, v60, v60 row_shr:4 row_mask:0xf bank_mask:0xa
    v_add_f32_dpp v48, v64, v64 row_shr:4 row_mask:0xf bank_mask:0xa
    v_add_f32_dpp v36, v36, v36 quad_perm:[1,0,3,2] row_mask:0xf bank_mask:0xf
    v_add_f32_dpp v40, v40, v40 quad_perm:[1,0,3,2] row_mask:0xf bank_mask:0xf
    v_add_f32_dpp v44, v44, v44 quad_perm:[1,0,3,2] row_mask:0xf bank_mask:0xf
    v_add_f32_dpp v48, v48, v48 quad_perm:[1,0,3,2] row_mask:0xf bank_mask:0xf
    v_add_f32_dpp v36, v36, v36 quad_perm:[2,3,0,1] row_mask:0xf bank_mask:0xf
    v_add_f32_dpp v40, v40, v40 quad_perm:[2,3,0,1] row_mask:0xf bank_mask:0xf
    v_add_f32_dpp v44, v44, v44 quad_perm:[2,3,0,1] row_mask:0xf bank_mask:0xf
    v_add_f32_dpp v48, v48, v48 quad_perm:[2,3,0,1] row_mask:0xf bank_mask:0xf
    s_mov_b32 s48, 0x3db504f3
    v_cvt_pk_bf16_f32 v16, v36, v40
    v_cvt_pk_bf16_f32 v17, v44, v48
    v_lshlrev_b32 v36, 16, v16
    v_and_b32 v40, 0xffff0000, v16
    v_lshlrev_b32 v44, 16, v17
    v_and_b32 v48, 0xffff0000, v17
    v_mul_f32 v36, s48, v36
    v_mul_f32 v40, s48, v40
    v_mul_f32 v44, s48, v44
    v_mul_f32 v48, s48, v48
    v_cvt_pk_bf16_f32 v16, v36, v40
    v_cvt_pk_bf16_f32 v17, v44, v48
    v_lshlrev_b32 v36, 16, v16
    v_and_b32 v40, 0xffff0000, v16
    v_lshlrev_b32 v44, 16, v17
    v_and_b32 v48, 0xffff0000, v17
    v_max_f32 v16, v36, v40
    v_max3_f32 v16, v44, v48, v16
    s_nop 1
    v_max_f32_dpp v16, v16, v16 row_ror:4 row_mask:0xf bank_mask:0xf
    s_nop 1
    v_max_f32_dpp v16, v16, v16 row_ror:8 row_mask:0xf bank_mask:0xf
    v_mov_b32 v17, v16
    s_nop 1
    v_permlane16_swap_b32 v17, v16
    v_max_f32 v16, v16, v17
    v_mov_b32 v17, v16
    s_nop 1
    v_permlane32_swap_b32 v17, v16
    v_max_f32 v16, v16, v17
    s_mov_b32 s48, 0x3fb8aa3b
    v_mul_f32 v16, s48, v16
    v_fma_f32 v36, v36, s48, -v16
    v_fma_f32 v40, v40, s48, -v16
    v_fma_f32 v44, v44, s48, -v16
    v_fma_f32 v48, v48, s48, -v16
    v_exp_f32 v36, v36
    v_exp_f32 v40, v40
    v_exp_f32 v44, v44
    v_exp_f32 v48, v48
    v_add_f32 v17, v36, v40
    v_add_f32 v18, v44, v48
    v_cvt_pk_bf16_f32 v24, v36, v36
    v_cvt_pk_bf16_f32 v25, v40, v40
    v_cvt_pk_bf16_f32 v26, v44, v44
    v_cvt_pk_bf16_f32 v27, v48, v48
    v_add_f32 v17, v17, v18
    s_nop 1
    v_add_f32_dpp v17, v17, v17 row_ror:4 row_mask:0xf bank_mask:0xf
    s_nop 1
    v_add_f32_dpp v17, v17, v17 row_ror:8 row_mask:0xf bank_mask:0xf
    v_mov_b32 v18, v17
    s_nop 1
    v_permlane16_swap_b32 v18, v17
    v_add_f32 v17, v17, v18
    v_mov_b32 v18, v17
    s_nop 1
    v_permlane32_swap_b32 v18, v17
    v_add_f32 v17, v17, v18
    s_lshl_b32 s49, s6, 3
    s_add_u32 s49, s49, 1536
    v_mov_b32 v18, s49
    s_mov_b64 exec, 1
    ds_write_b64 v18, v[16:17]
    ds_add_u32 v13, v14 offset:16
    s_mov_b64 exec, -1
    v_lshlrev_b32 v12, 5, v1
    v_lshl_add_u32 v12, v2, 4, v12
    s_lshl_b32 s49, s6, 9
    s_add_u32 s49, s49, 2048
    v_add_u32 v12, s49, v12
    v_and_b32_dpp v28, v24, v8 row_newbcast:0 row_mask:0xf bank_mask:0xf
    v_and_b32_dpp v29, v24, v9 row_newbcast:0 row_mask:0xf bank_mask:0xf
    v_and_b32_dpp v30, v24, v10 row_newbcast:0 row_mask:0xf bank_mask:0xf
    v_and_b32_dpp v31, v24, v11 row_newbcast:0 row_mask:0xf bank_mask:0xf
    v_and_b32_dpp v32, v25, v8 row_newbcast:0 row_mask:0xf bank_mask:0xf
    v_and_b32_dpp v33, v25, v9 row_newbcast:0 row_mask:0xf bank_mask:0xf
    v_and_b32_dpp v34, v25, v10 row_newbcast:0 row_mask:0xf bank_mask:0xf
    v_and_b32_dpp v35, v25, v11 row_newbcast:0 row_mask:0xf bank_mask:0xf
    s_waitcnt vmcnt(15)
    v_mfma_f32_16x16x32_bf16 v[20:23], v[28:31], a[0:3], 0
    v_and_b32_dpp v28, v26, v8 row_newbcast:0 row_mask:0xf bank_mask:0xf
    v_and_b32_dpp v29, v26, v9 row_newbcast:0 row_mask:0xf bank_mask:0xf
    v_and_b32_dpp v30, v26, v10 row_newbcast:0 row_mask:0xf bank_mask:0xf
    v_and_b32_dpp v31, v26, v11 row_newbcast:0 row_mask:0xf bank_mask:0xf
    s_waitcnt vmcnt(14)
    v_mfma_f32_16x16x32_bf16 v[20:23], v[32:35], a[4:7], v[20:23]
    v_and_b32_dpp v32, v27, v8 row_newbcast:0 row_mask:0xf bank_mask:0xf
    v_and_b32_dpp v33, v27, v9 row_newbcast:0 row_mask:0xf bank_mask:0xf
    v_and_b32_dpp v34, v27, v10 row_newbcast:0 row_mask:0xf bank_mask:0xf
    v_and_b32_dpp v35, v27, v11 row_newbcast:0 row_mask:0xf bank_mask:0xf
    s_waitcnt vmcnt(13)
    v_mfma_f32_16x16x32_bf16 v[20:23], v[28:31], a[8:11], v[20:23]
    v_and_b32_dpp v28, v24, v8 row_newbcast:4 row_mask:0xf bank_mask:0xf
    v_and_b32_dpp v29, v24, v9 row_newbcast:4 row_mask:0xf bank_mask:0xf
    v_and_b32_dpp v30, v24, v10 row_newbcast:4 row_mask:0xf bank_mask:0xf
    v_and_b32_dpp v31, v24, v11 row_newbcast:4 row_mask:0xf bank_mask:0xf
    s_waitcnt vmcnt(12)
    v_mfma_f32_16x16x32_bf16 v[20:23], v[32:35], a[12:15], v[20:23]
    v_and_b32_dpp v32, v25, v8 row_newbcast:4 row_mask:0xf bank_mask:0xf
    v_and_b32_dpp v33, v25, v9 row_newbcast:4 row_mask:0xf bank_mask:0xf
    v_and_b32_dpp v34, v25, v10 row_newbcast:4 row_mask:0xf bank_mask:0xf
    v_and_b32_dpp v35, v25, v11 row_newbcast:4 row_mask:0xf bank_mask:0xf
    s_waitcnt vmcnt(11)
    v_mfma_f32_16x16x32_bf16 v[20:23], v[28:31], a[16:19], v[20:23]
    v_and_b32_dpp v28, v26, v8 row_newbcast:4 row_mask:0xf bank_mask:0xf
    v_and_b32_dpp v29, v26, v9 row_newbcast:4 row_mask:0xf bank_mask:0xf
    v_and_b32_dpp v30, v26, v10 row_newbcast:4 row_mask:0xf bank_mask:0xf
    v_and_b32_dpp v31, v26, v11 row_newbcast:4 row_mask:0xf bank_mask:0xf
    s_waitcnt vmcnt(10)
    v_mfma_f32_16x16x32_bf16 v[20:23], v[32:35], a[20:23], v[20:23]
    v_and_b32_dpp v32, v27, v8 row_newbcast:4 row_mask:0xf bank_mask:0xf
    v_and_b32_dpp v33, v27, v9 row_newbcast:4 row_mask:0xf bank_mask:0xf
    v_and_b32_dpp v34, v27, v10 row_newbcast:4 row_mask:0xf bank_mask:0xf
    v_and_b32_dpp v35, v27, v11 row_newbcast:4 row_mask:0xf bank_mask:0xf
    s_waitcnt vmcnt(9)
    v_mfma_f32_16x16x32_bf16 v[20:23], v[28:31], a[24:27], v[20:23]
    v_and_b32_dpp v28, v24, v8 row_newbcast:8 row_mask:0xf bank_mask:0xf
    v_and_b32_dpp v29, v24, v9 row_newbcast:8 row_mask:0xf bank_mask:0xf
    v_and_b32_dpp v30, v24, v10 row_newbcast:8 row_mask:0xf bank_mask:0xf
    v_and_b32_dpp v31, v24, v11 row_newbcast:8 row_mask:0xf bank_mask:0xf
    s_waitcnt vmcnt(8)
    v_mfma_f32_16x16x32_bf16 v[20:23], v[32:35], a[28:31], v[20:23]
    v_and_b32_dpp v32, v25, v8 row_newbcast:8 row_mask:0xf bank_mask:0xf
    v_and_b32_dpp v33, v25, v9 row_newbcast:8 row_mask:0xf bank_mask:0xf
    v_and_b32_dpp v34, v25, v10 row_newbcast:8 row_mask:0xf bank_mask:0xf
    v_and_b32_dpp v35, v25, v11 row_newbcast:8 row_mask:0xf bank_mask:0xf
    s_waitcnt vmcnt(7)
    v_mfma_f32_16x16x32_bf16 v[20:23], v[28:31], a[32:35], v[20:23]
    v_and_b32_dpp v28, v26, v8 row_newbcast:8 row_mask:0xf bank_mask:0xf
    v_and_b32_dpp v29, v26, v9 row_newbcast:8 row_mask:0xf bank_mask:0xf
    v_and_b32_dpp v30, v26, v10 row_newbcast:8 row_mask:0xf bank_mask:0xf
    v_and_b32_dpp v31, v26, v11 row_newbcast:8 row_mask:0xf bank_mask:0xf
    s_waitcnt vmcnt(6)
    v_mfma_f32_16x16x32_bf16 v[20:23], v[32:35], a[36:39], v[20:23]
    v_and_b32_dpp v32, v27, v8 row_newbcast:8 row_mask:0xf bank_mask:0xf
    v_and_b32_dpp v33, v27, v9 row_newbcast:8 row_mask:0xf bank_mask:0xf
    v_and_b32_dpp v34, v27, v10 row_newbcast:8 row_mask:0xf bank_mask:0xf
    v_and_b32_dpp v35, v27, v11 row_newbcast:8 row_mask:0xf bank_mask:0xf
    s_waitcnt vmcnt(5)
    v_mfma_f32_16x16x32_bf16 v[20:23], v[28:31], a[40:43], v[20:23]
    v_and_b32_dpp v28, v24, v8 row_newbcast:12 row_mask:0xf bank_mask:0xf
    v_and_b32_dpp v29, v24, v9 row_newbcast:12 row_mask:0xf bank_mask:0xf
    v_and_b32_dpp v30, v24, v10 row_newbcast:12 row_mask:0xf bank_mask:0xf
    v_and_b32_dpp v31, v24, v11 row_newbcast:12 row_mask:0xf bank_mask:0xf
    s_waitcnt vmcnt(4)
    v_mfma_f32_16x16x32_bf16 v[20:23], v[32:35], a[44:47], v[20:23]
    v_and_b32_dpp v32, v25, v8 row_newbcast:12 row_mask:0xf bank_mask:0xf
    v_and_b32_dpp v33, v25, v9 row_newbcast:12 row_mask:0xf bank_mask:0xf
    v_and_b32_dpp v34, v25, v10 row_newbcast:12 row_mask:0xf bank_mask:0xf
    v_and_b32_dpp v35, v25, v11 row_newbcast:12 row_mask:0xf bank_mask:0xf
    s_waitcnt vmcnt(3)
    v_mfma_f32_16x16x32_bf16 v[20:23], v[28:31], a[48:51], v[20:23]
    v_and_b32_dpp v28, v26, v8 row_newbcast:12 row_mask:0xf bank_mask:0xf
    v_and_b32_dpp v29, v26, v9 row_newbcast:12 row_mask:0xf bank_mask:0xf
    v_and_b32_dpp v30, v26, v10 row_newbcast:12 row_mask:0xf bank_mask:0xf
    v_and_b32_dpp v31, v26, v11 row_newbcast:12 row_mask:0xf bank_mask:0xf
    s_waitcnt vmcnt(2)
    v_mfma_f32_16x16x32_bf16 v[20:23], v[32:35], a[52:55], v[20:23]
    v_and_b32_dpp v32, v27, v8 row_newbcast:12 row_mask:0xf bank_mask:0xf
    v_and_b32_dpp v33, v27, v9 row_newbcast:12 row_mask:0xf bank_mask:0xf
    v_and_b32_dpp v34, v27, v10 row_newbcast:12 row_mask:0xf bank_mask:0xf
    v_and_b32_dpp v35, v27, v11 row_newbcast:12 row_mask:0xf bank_mask:0xf
    s_waitcnt vmcnt(1)
    v_mfma_f32_16x16x32_bf16 v[20:23], v[28:31], a[56:59], v[20:23]
    s_waitcnt vmcnt(0)
    v_mfma_f32_16x16x32_bf16 v[20:23], v[32:35], a[60:63], v[20:23]
    s_mov_b32 exec_hi, 0
    s_nop 6
    ds_write_b128 v12, v[20:23]
    s_mov_b32 exec_hi, -1
    s_waitcnt lgkmcnt(0)
    s_barrier
    s_endpgm
L_SV_TAILLOAD:
    s_mul_i32 s56, s6, 52429
    s_lshr_b32 s56, s56, 18
    s_mul_i32 s57, s56, 5
    s_sub_u32 s57, s6, s57
    s_cmp_eq_u32 s7, 0
    s_cselect_b32 s40, s16, s24
    s_cselect_b32 s41, s17, s25
    s_mov_b32 s42, 5242880
    s_cselect_b32 s42, s42, 2211840
    s_cselect_b32 s56, s4, s56
    s_cselect_b32 s57, s98, s57
    s_and_b32 s41, s41, 0xffff
    s_mov_b32 s43, 0x20000
    s_lshl_b32 s58, s56, 7
    s_lshl_b32 s59, s3, 5
    s_add_u32 s58, s58, s59
    s_mul_i32 s58, s58, 1280
    s_lshl_b32 s59, s57, 8
    s_add_u32 s58, s58, s59
    s_add_u32 s59, s58, 5120
    v_mul_u32_u24 v6, 10240, v2
    v_lshl_add_u32 v6, v1, 4, v6
    s_cmp_eq_u32 s7, 1
    s_cselect_b32 s49, s56, 0
    s_cmp_eq_u32 s49, 13
    s_cselect_b32 s49, s3, 0
    s_cmp_ge_u32 s7, 2
    s_cselect_b32 s49, 3, s49
    s_cmp_ge_u32 s49, 2
    s_cbranch_scc0 L_SV_TL2
    v_mov_b32 v6, 0x7ffffff0
L_SV_TL2:
    v_mov_b32 v17, 260
L_SV_ISSW:
    ds_read_b32 v18, v17
    s_waitcnt lgkmcnt(0)
    v_readfirstlane_b32 s48, v18
    s_nop 0
    s_cmp_ge_u32 s48, 8
    s_cbranch_scc1 L_SV_ISSW_OK
    s_sleep 4
    s_branch L_SV_ISSW
L_SV_ISSW_OK:
    s_cmp_eq_u32 s3, 0
    s_cbranch_scc0 L_SV_NOGUP
    s_cmp_eq_u32 s61, 1
    s_cbranch_scc0 L_SV_NOGUP
    v_mov_b32 v17, 268
L_SV_CLRW2:
    ds_read_b32 v18, v17
    s_waitcnt lgkmcnt(0)
    v_readfirstlane_b32 s48, v18
    s_nop 0
    s_cmp_lg_u32 s48, 0
    s_cbranch_scc1 L_SV_CLRW2_OK
    s_sleep 4
    s_branch L_SV_CLRW2
L_SV_CLRW2_OK:
    v_lshlrev_b32 v7, 4, v0
    buffer_store_dwordx4 v[96:99], v7, s[32:35], s63 offen sc1
L_SV_NOGUP:
    s_cmp_ge_u32 s7, 2
    s_cbranch_scc1 L_SV_BAR2
    buffer_load_dwordx4 a[0:3], v6, s[40:43], s58 offen offset:0 nt
    buffer_load_dwordx4 a[4:7], v6, s[40:43], s58 offen offset:1280 nt
    buffer_load_dwordx4 a[8:11], v6, s[40:43], s58 offen offset:2560 nt
    buffer_load_dwordx4 a[12:15], v6, s[40:43], s58 offen offset:3840 nt
    buffer_load_dwordx4 a[16:19], v6, s[40:43], s59 offen offset:0 nt
    buffer_load_dwordx4 a[20:23], v6, s[40:43], s59 offen offset:1280 nt
    buffer_load_dwordx4 a[24:27], v6, s[40:43], s59 offen offset:2560 nt
    buffer_load_dwordx4 a[28:31], v6, s[40:43], s59 offen offset:3840 nt
L_SV_BAR2:
    s_cmp_eq_u32 s3, 0
    s_cbranch_scc0 L_SV_BAR2B
    v_mov_b32 v17, 272
L_SV_MLW:
    ds_read_b32 v18, v17
    s_waitcnt lgkmcnt(0)
    v_readfirstlane_b32 s48, v18
    s_nop 0
    s_cmp_ge_u32 s48, 8
    s_cbranch_scc1 L_SV_MLW_OK
    s_sleep 4
    s_branch L_SV_MLW
L_SV_MLW_OK:
    v_mov_b32 v60, 1536
    ds_read_b128 v[20:23], v60
    ds_read_b128 v[24:27], v60 offset:16
    ds_read_b128 v[28:31], v60 offset:32
    ds_read_b128 v[32:35], v60 offset:48
    v_mov_b32 v60, 0
    s_waitcnt lgkmcnt(0)
    v_max3_f32 v36, v20, v22, v24
    v_max3_f32 v37, v26, v28, v30
    v_max3_f32 v36, v36, v32, v34
    v_max_f32 v36, v36, v37
    v_sub_f32 v20, v20, v36
    v_sub_f32 v22, v22, v36
    v_sub_f32 v24, v24, v36
    v_sub_f32 v26, v26, v36
    v_sub_f32 v28, v28, v36
    v_sub_f32 v30, v30, v36
    v_sub_f32 v32, v32, v36
    v_sub_f32 v34, v34, v36
    v_exp_f32 v20, v20
    v_exp_f32 v22, v22
    v_exp_f32 v24, v24
    v_exp_f32 v26, v26
    v_exp_f32 v28, v28
    v_exp_f32 v30, v30
    v_exp_f32 v32, v32
    v_exp_f32 v34, v34
    v_mul_f32 v37, v20, v21
    v_fmac_f32 v37, v22, v23
    v_fmac_f32 v37, v24, v25
    v_fmac_f32 v37, v26, v27
    v_fmac_f32 v37, v28, v29
    v_fmac_f32 v37, v30, v31
    v_fmac_f32 v37, v32, v33
    v_fmac_f32 v37, v34, v35
    v_min_u32 v36, -2, v36
    v_min_u32 v37, -2, v37
    s_mov_b64 exec, 1
    buffer_store_dwordx2 v[36:37], v60, s[32:35], s97 offen sc1
    s_mov_b64 exec, -1
L_SV_BAR2B:
    s_waitcnt lgkmcnt(0)
    s_barrier
    s_cmp_eq_u32 s3, 0
    s_cbranch_scc0 L_SV_POSTPUB
    v_lshlrev_b32 v61, 3, v0
    ds_read_b64 v[40:41], v61 offset:2048
    ds_read_b64 v[42:43], v61 offset:2560
    ds_read_b64 v[44:45], v61 offset:3072
    ds_read_b64 v[46:47], v61 offset:3584
    ds_read_b64 v[48:49], v61 offset:4096
    ds_read_b64 v[50:51], v61 offset:4608
    ds_read_b64 v[52:53], v61 offset:5120
    ds_read_b64 v[54:55], v61 offset:5632
    s_waitcnt lgkmcnt(4)
    v_mul_f32 v38, v20, v40
    v_mul_f32 v39, v20, v41
    v_fmac_f32 v38, v22, v42
    v_fmac_f32 v39, v22, v43
    v_fmac_f32 v38, v24, v44
    v_fmac_f32 v39, v24, v45
    v_fmac_f32 v38, v26, v46
    v_fmac_f32 v39, v26, v47
    s_waitcnt lgkmcnt(0)
    v_fmac_f32 v38, v28, v48
    v_fmac_f32 v39, v28, v49
    v_fmac_f32 v38, v30, v50
    v_fmac_f32 v39, v30, v51
    v_fmac_f32 v38, v32, v52
    v_fmac_f32 v39, v32, v53
    v_fmac_f32 v38, v34, v54
    v_fmac_f32 v39, v34, v55
    v_min_u32 v38, -2, v38
    v_min_u32 v39, -2, v39
    buffer_store_dwordx2 v[38:39], v61, s[32:35], s96 offen sc1
L_SV_POSTPUB:
    s_cmp_eq_u32 s7, 0
    s_cbranch_scc1 L_SV_OGATH
    s_cmp_eq_u32 s7, 1
    s_cbranch_scc1 L_SV_HGATH
    s_cmp_eq_u32 s7, 2
    s_cbranch_scc0 L_SV_EXIT
    s_cmp_ge_u32 s3, 2
    s_cbranch_scc1 L_FINAL
    s_branch L_SV_EXIT
L_SV_HGATH:
    s_cmp_eq_u32 s3, 1
    s_cbranch_scc0 L_SV_HDONE
L_SV_HSETUP:
    v_lshlrev_b32 v6, 4, v0
    s_lshl_b32 s54, s56, 12
    s_add_u32 s54, s54, 0
    s_add_u32 s55, s54, 57344
    s_mov_b32 s53, 0
L_SV_HP:
    buffer_load_dwordx4 v[20:23], v6, s[32:35], s54 offen offset:0 sc1
    buffer_load_dwordx4 v[24:27], v6, s[32:35], s54 offen offset:1024 sc1
    buffer_load_dwordx4 v[28:31], v6, s[32:35], s54 offen offset:2048 sc1
    buffer_load_dwordx4 v[32:35], v6, s[32:35], s54 offen offset:3072 sc1
    buffer_load_dwordx4 v[52:55], v6, s[32:35], s55 offen offset:0 sc1
    buffer_load_dwordx4 v[56:59], v6, s[32:35], s55 offen offset:1024 sc1
    buffer_load_dwordx4 v[60:63], v6, s[32:35], s55 offen offset:2048 sc1
    buffer_load_dwordx4 v[64:67], v6, s[32:35], s55 offen offset:3072 sc1
    s_add_u32 s53, s53, 1
    s_waitcnt vmcnt(4)
    v_max3_u32 v84, v20, v21, v22
    v_max3_u32 v85, v23, v24, v25
    v_max3_u32 v84, v84, v26, v27
    v_max3_u32 v85, v85, v28, v29
    v_max3_u32 v84, v84, v30, v31
    v_max3_u32 v85, v85, v32, v33
    v_max3_u32 v84, v84, v34, v35
    s_waitcnt vmcnt(0)
    v_max3_u32 v84, v84, v52, v53
    v_max3_u32 v85, v85, v54, v55
    v_max3_u32 v84, v84, v56, v57
    v_max3_u32 v85, v85, v58, v59
    v_max3_u32 v84, v84, v60, v61
    v_max3_u32 v85, v85, v62, v63
    v_max3_u32 v84, v84, v64, v65
    v_max3_u32 v85, v85, v66, v67
    v_max_u32 v84, v84, v85
    v_cmp_eq_u32 vcc, -1, v84
    s_cmp_gt_u32 s53, 20000
    s_cbranch_scc1 L_SV_HOK
    s_cbranch_vccz L_SV_HOK
    s_sleep 8
    s_branch L_SV_HP
L_SV_HOK:
    v_add_f32 v20, v20, v24
    v_add_f32 v28, v28, v32
    v_add_f32 v21, v21, v25
    v_add_f32 v29, v29, v33
    v_add_f32 v22, v22, v26
    v_add_f32 v30, v30, v34
    v_add_f32 v23, v23, v27
    v_add_f32 v31, v31, v35
    v_add_f32 v20, v20, v28
    v_add_f32 v21, v21, v29
    v_add_f32 v22, v22, v30
    v_add_f32 v23, v23, v31
    v_add_f32 v52, v52, v56
    v_add_f32 v60, v60, v64
    v_add_f32 v53, v53, v57
    v_add_f32 v61, v61, v65
    v_add_f32 v54, v54, v58
    v_add_f32 v62, v62, v66
    v_add_f32 v55, v55, v59
    v_add_f32 v63, v63, v67
    v_add_f32 v52, v52, v60
    v_add_f32 v53, v53, v61
    v_add_f32 v54, v54, v62
    v_add_f32 v55, v55, v63
    v_cvt_pk_bf16_f32 v24, v20, v21
    v_cvt_pk_bf16_f32 v25, v22, v23
    v_cvt_pk_bf16_f32 v26, v52, v53
    v_cvt_pk_bf16_f32 v27, v54, v55
    v_lshlrev_b32 v20, 16, v24
    v_and_b32 v21, 0xffff0000, v24
    v_lshlrev_b32 v22, 16, v25
    v_and_b32 v23, 0xffff0000, v25
    v_lshlrev_b32 v52, 16, v26
    v_and_b32 v53, 0xffff0000, v26
    v_lshlrev_b32 v54, 16, v27
    v_and_b32 v55, 0xffff0000, v27
    s_mov_b32 s54, 0x3d372713
    s_mov_b32 s55, 0xc0135761
    v_mul_f32 v28, v20, v20
    v_mul_f32 v29, v21, v21
    v_mul_f32 v30, v22, v22
    v_mul_f32 v31, v23, v23
    v_fma_f32 v28, v28, s54, 1.0
    v_fma_f32 v29, v29, s54, 1.0
    v_fma_f32 v30, v30, s54, 1.0
    v_fma_f32 v31, v31, s54, 1.0
    v_mul_f32 v28, v28, v20
    v_mul_f32 v29, v29, v21
    v_mul_f32 v30, v30, v22
    v_mul_f32 v31, v31, v23
    v_mul_f32 v28, s55, v28
    v_mul_f32 v29, s55, v29
    v_mul_f32 v30, s55, v30
    v_mul_f32 v31, s55, v31
    v_exp_f32 v28, v28
    v_exp_f32 v29, v29
    v_exp_f32 v30, v30
    v_exp_f32 v31, v31
    v_add_f32 v28, 1.0, v28
    v_add_f32 v29, 1.0, v29
    v_add_f32 v30, 1.0, v30
    v_add_f32 v31, 1.0, v31
    v_rcp_f32 v28, v28
    v_rcp_f32 v29, v29
    v_rcp_f32 v30, v30
    v_rcp_f32 v31, v31
    v_mul_f32 v28, v28, v20
    v_mul_f32 v29, v29, v21
    v_mul_f32 v30, v30, v22
    v_mul_f32 v31, v31, v23
    v_cvt_pk_bf16_f32 v28, v28, v28
    v_cvt_pk_bf16_f32 v29, v29, v29
    v_cvt_pk_bf16_f32 v30, v30, v30
    v_cvt_pk_bf16_f32 v31, v31, v31
    v_and_b32 v28, 0xffff0000, v28
    v_and_b32 v29, 0xffff0000, v29
    v_and_b32 v30, 0xffff0000, v30
    v_and_b32 v31, 0xffff0000, v31
    v_mul_f32 v28, v28, v52
    v_mul_f32 v29, v29, v53
    v_mul_f32 v30, v30, v54
    v_mul_f32 v31, v31, v55
    v_cvt_pk_bf16_f32 v28, v28, v28
    v_cvt_pk_bf16_f32 v29, v29, v29
    v_cvt_pk_bf16_f32 v30, v30, v30
    v_cvt_pk_bf16_f32 v31, v31, v31
    v_lshrrev_b32 v6, 5, v0
    v_lshlrev_b32 v6, 9, v6
    v_lshl_add_u32 v6, v1, 5, v6
    v_and_b32 v7, 1, v2
    v_lshl_add_u32 v6, v7, 4, v6
    ds_write_b128 v6, v[28:31] offset:512
    s_waitcnt lgkmcnt(0)
L_SV_HDONE:
    s_barrier
    s_branch L_SV_GEMV2
L_SV_OGATH:
    v_bfe_u32 v60, v0, 3, 1
    v_mul_u32_u24 v61, 2048, v60
    v_and_b32 v62, 7, v0
    v_lshl_add_u32 v62, v2, 3, v62
    v_lshl_add_u32 v63, v62, 2, v61
    v_and_b32 v64, 3, v0
    v_lshl_add_u32 v64, v60, 2, v64
    v_lshlrev_b32 v64, 3, v64
    s_mul_i32 s48, s4, 4096
    s_add_u32 s48, s48, 262144
    s_lshl_b32 s49, s4, 7
    s_add_u32 s49, s49, 925696
    s_lshl_b32 s50, s3, 7
    s_add_u32 s48, s48, s50
    v_lshlrev_b32 v65, 9, v60
    v_lshl_add_u32 v65, v62, 2, v65
    s_add_u32 s50, s50, 512
    v_add_u32 v65, s50, v65
    s_mov_b32 s53, 0
    s_cmp_eq_u32 s3, 0
    s_cbranch_scc0 L_SV_MB
L_SV_MP:
    buffer_load_dwordx2 v[20:21], v64, s[32:35], s49 offen sc1
    s_add_u32 s53, s53, 1
    s_waitcnt vmcnt(0)
    v_max_u32 v26, v20, v21
    v_cmp_eq_u32 vcc, -1, v26
    s_cmp_gt_u32 s53, 40000
    s_cbranch_scc1 L_SV_MB
    s_bcnt1_i32_b64 s54, vcc
    s_cmp_le_u32 s54, 8
    s_cbranch_scc1 L_SV_MB
    s_sleep 1
    s_branch L_SV_MP
L_SV_MB:
    s_barrier
L_SV_OP:
    buffer_load_dwordx2 v[20:21], v64, s[32:35], s49 offen sc1
    buffer_load_dword v22, v63, s[32:35], s48 offen sc1
    buffer_load_dword v23, v63, s[32:35], s48 offen offset:512 sc1
    buffer_load_dword v24, v63, s[32:35], s48 offen offset:1024 sc1
    buffer_load_dword v25, v63, s[32:35], s48 offen offset:1536 sc1
    s_add_u32 s53, s53, 1
    s_waitcnt vmcnt(4)
    v_max_f32_dpp v26, v20, v20 quad_perm:[1,0,3,2] row_mask:0xf bank_mask:0xf
    s_nop 1
    v_max_f32_dpp v26, v26, v26 quad_perm:[2,3,0,1] row_mask:0xf bank_mask:0xf
    v_sub_f32 v30, v20, v26
    v_exp_f32 v30, v30
    s_nop 0
    v_mul_f32 v31, v30, v21
    s_nop 1
    v_add_f32_dpp v27, v31, v31 quad_perm:[1,0,3,2] row_mask:0xf bank_mask:0xf
    s_nop 1
    v_add_f32_dpp v27, v27, v27 quad_perm:[2,3,0,1] row_mask:0xf bank_mask:0xf
    v_rcp_f32 v27, v27
    s_nop 0
    v_mul_f32 v30, v30, v27
    s_waitcnt vmcnt(0)
    v_max3_u32 v26, v22, v23, v24
    v_max3_u32 v27, v20, v21, v25
    v_max_u32 v26, v26, v27
    v_cmp_eq_u32 vcc, -1, v26
    s_cmp_gt_u32 s53, 80000
    s_cbranch_scc1 L_SV_OOK
    s_cbranch_vccz L_SV_OOK
    s_sleep 1
    s_branch L_SV_OP
L_SV_OOK:
    v_mul_f32_dpp v28, v30, v22 quad_perm:[0,0,0,0] row_mask:0xf bank_mask:0xf
    s_nop 1
    v_fmac_f32_dpp v28, v30, v23 quad_perm:[1,1,1,1] row_mask:0xf bank_mask:0xf
    s_nop 1
    v_fmac_f32_dpp v28, v30, v24 quad_perm:[2,2,2,2] row_mask:0xf bank_mask:0xf
    s_nop 1
    v_fmac_f32_dpp v28, v30, v25 quad_perm:[3,3,3,3] row_mask:0xf bank_mask:0xf
    v_cvt_pk_bf16_f32 v28, v28, v28
    ds_write_b32 v65, v28
L_SV_GEMV2:
    v_bfe_u32 v60, v0, 3, 1
    v_lshlrev_b32 v60, 9, v60
    v_lshl_add_u32 v60, v2, 5, v60
    s_lshl_b32 s50, s3, 7
    s_add_u32 s50, s50, 512
    v_add_u32 v60, s50, v60
    ds_read_b128 v[40:43], v60
    ds_read_b128 v[44:47], v60 offset:16
    v_lshlrev_b32 v60, 4, v0
    s_lshl_b32 s50, s3, 10
    s_add_u32 s50, s50, 6144
    v_add_u32 v61, s50, v60
    s_waitcnt lgkmcnt(0)
    v_and_b32 v88, v40, v8
    v_and_b32 v89, v40, v9
    v_and_b32 v90, v40, v10
    v_and_b32 v91, v40, v11
    v_and_b32 v92, v41, v8
    v_and_b32 v93, v41, v9
    v_and_b32 v94, v41, v10
    v_and_b32 v95, v41, v11
    s_waitcnt vmcnt(7)
    v_mfma_f32_16x16x32_bf16 v[84:87], v[88:91], a[0:3], 0
    v_and_b32 v88, v42, v8
    v_and_b32 v89, v42, v9
    v_and_b32 v90, v42, v10
    v_and_b32 v91, v42, v11
    s_waitcnt vmcnt(6)
    v_mfma_f32_16x16x32_bf16 v[84:87], v[92:95], a[4:7], v[84:87]
    v_and_b32 v92, v43, v8
    v_and_b32 v93, v43, v9
    v_and_b32 v94, v43, v10
    v_and_b32 v95, v43, v11
    s_waitcnt vmcnt(5)
    v_mfma_f32_16x16x32_bf16 v[84:87], v[88:91], a[8:11], v[84:87]
    v_and_b32 v88, v44, v8
    v_and_b32 v89, v44, v9
    v_and_b32 v90, v44, v10
    v_and_b32 v91, v44, v11
    s_waitcnt vmcnt(4)
    v_mfma_f32_16x16x32_bf16 v[84:87], v[92:95], a[12:15], v[84:87]
    v_and_b32 v92, v45, v8
    v_and_b32 v93, v45, v9
    v_and_b32 v94, v45, v10
    v_and_b32 v95, v45, v11
    s_waitcnt vmcnt(3)
    v_mfma_f32_16x16x32_bf16 v[84:87], v[88:91], a[16:19], v[84:87]
    v_and_b32 v88, v46, v8
    v_and_b32 v89, v46, v9
    v_and_b32 v90, v46, v10
    v_and_b32 v91, v46, v11
    s_waitcnt vmcnt(2)
    v_mfma_f32_16x16x32_bf16 v[84:87], v[92:95], a[20:23], v[84:87]
    v_and_b32 v92, v47, v8
    v_and_b32 v93, v47, v9
    v_and_b32 v94, v47, v10
    v_and_b32 v95, v47, v11
    s_waitcnt vmcnt(1)
    v_mfma_f32_16x16x32_bf16 v[84:87], v[88:91], a[24:27], v[84:87]
    s_waitcnt vmcnt(0)
    v_mfma_f32_16x16x32_bf16 v[84:87], v[92:95], a[28:31], v[84:87]
    s_nop 7
    ds_write_b128 v61, v[84:87]
    s_waitcnt lgkmcnt(0)
    s_barrier
    s_cmp_eq_u32 s3, 0
    s_cbranch_scc0 L_SV_EXIT
    ds_read_b128 v[20:23], v60 offset:6144
    ds_read_b128 v[24:27], v60 offset:7168
    ds_read_b128 v[28:31], v60 offset:8192
    ds_read_b128 v[32:35], v60 offset:9216
    s_waitcnt lgkmcnt(0)
    v_add_f32 v20, v20, v24
    v_add_f32 v28, v28, v32
    v_add_f32 v21, v21, v25
    v_add_f32 v29, v29, v33
    v_add_f32 v22, v22, v26
    v_add_f32 v30, v30, v34
    v_add_f32 v23, v23, v27
    v_add_f32 v31, v31, v35
    v_add_f32 v20, v20, v28
    v_add_f32 v21, v21, v29
    v_add_f32 v22, v22, v30
    v_add_f32 v23, v23, v31
    v_min_u32 v20, -2, v20
    v_min_u32 v21, -2, v21
    v_min_u32 v22, -2, v22
    v_min_u32 v23, -2, v23
    buffer_store_dwordx4 v[20:23], v60, s[32:35], s62 offen sc1
    s_branch L_SV_EXIT
L_FINAL:
    s_sub_u32 s44, s6, 70
    s_lshl_b32 s44, s44, 1
    s_add_u32 s44, s44, s3
    s_sub_u32 s44, s44, 2
    s_lshr_b32 s45, s44, 3
    s_bfe_u32 s46, s44, 0x10002
    s_and_b32 s47, s44, 3
    s_mov_b32 s36, s8
    s_and_b32 s37, s9, 0xffff
    s_mov_b32 s38, 2560
    s_mov_b32 s39, 0x20000
    s_mov_b32 s40, s26
    s_and_b32 s41, s27, 0xffff
    s_mov_b32 s42, 2560
    s_mov_b32 s43, 0x20000
    s_mul_i32 s48, s46, 1280
    s_lshl_b32 s49, s45, 8
    s_add_u32 s48, s48, s49
    s_and_b32 s49, s47, 1
    s_lshl_b32 s49, s49, 7
    s_add_u32 s48, s48, s49
    s_lshr_b32 s49, s47, 1
    s_lshl_b32 s49, s49, 3
    s_add_u32 s48, s48, s49
    v_and_b32 v61, 7, v0
    v_lshlrev_b32 v62, 4, v61
    buffer_load_dwordx2 v[50:51], v62, s[36:39], s48 offen
    v_lshrrev_b32 v60, 3, v0
    v_mul_u32_u24 v63, 5120, v60
    v_lshl_add_u32 v63, v61, 4, v63
    v_mov_b32 v64, 0x7ffffff0
    v_cmp_gt_u32 vcc, 6, v60
    s_nop 1
    v_cndmask_b32 v64, v64, v63, vcc
    s_lshl_b32 s49, s45, 10
    s_lshl_b32 s50, s46, 9
    s_add_u32 s49, s49, s50
    s_lshl_b32 s50, s47, 7
    s_add_u32 s49, s49, s50
    s_add_u32 s49, s49, 393216
    s_add_u32 s50, s49, 163840
    s_add_u32 s51, s50, 40960
    s_add_u32 s55, s49, 40960
    s_add_u32 s56, s49, 81920
    s_add_u32 s57, s49, 122880
    s_mov_b32 s53, 0
L_FN_P1:
    buffer_load_dwordx4 v[20:23], v63, s[32:35], s50 offen sc1
    buffer_load_dwordx4 v[24:27], v64, s[32:35], s51 offen sc1
    buffer_load_dwordx4 v[66:69], v63, s[32:35], s49 offen sc1
    buffer_load_dwordx4 v[70:73], v63, s[32:35], s55 offen sc1
    buffer_load_dwordx4 v[74:77], v63, s[32:35], s56 offen sc1
    buffer_load_dwordx4 v[78:81], v63, s[32:35], s57 offen sc1
    s_add_u32 s53, s53, 1
    s_waitcnt vmcnt(4)
    v_max3_u32 v28, v20, v21, v22
    v_max3_u32 v29, v23, v24, v25
    v_max3_u32 v28, v28, v26, v27
    v_max_u32 v28, v28, v29
    v_cmp_eq_u32 vcc, -1, v28
    s_cmp_gt_u32 s53, 20000
    s_cbranch_scc1 L_FN_OK1
    s_cbranch_vccnz L_FN_P1
L_FN_OK1:
    v_add_f32 v20, v20, v24
    v_add_f32 v21, v21, v25
    v_add_f32 v22, v22, v26
    v_add_f32 v23, v23, v27
    v_add_f32_dpp v20, v20, v20 row_ror:8 row_mask:0xf bank_mask:0xf
    v_add_f32_dpp v21, v21, v21 row_ror:8 row_mask:0xf bank_mask:0xf
    v_add_f32_dpp v22, v22, v22 row_ror:8 row_mask:0xf bank_mask:0xf
    v_add_f32_dpp v23, v23, v23 row_ror:8 row_mask:0xf bank_mask:0xf
    v_mov_b32 v24, v20
    v_mov_b32 v25, v21
    v_mov_b32 v26, v22
    v_mov_b32 v27, v23
    v_permlane16_swap_b32 v24, v20
    v_permlane16_swap_b32 v25, v21
    v_permlane16_swap_b32 v26, v22
    v_permlane16_swap_b32 v27, v23
    v_add_f32 v20, v20, v24
    v_add_f32 v21, v21, v25
    v_add_f32 v22, v22, v26
    v_add_f32 v23, v23, v27
    v_mov_b32 v24, v20
    v_mov_b32 v25, v21
    v_mov_b32 v26, v22
    v_mov_b32 v27, v23
    v_permlane32_swap_b32 v24, v20
    v_permlane32_swap_b32 v25, v21
    v_permlane32_swap_b32 v26, v22
    v_permlane32_swap_b32 v27, v23
    v_add_f32 v20, v20, v24
    v_add_f32 v21, v21, v25
    v_add_f32 v22, v22, v26
    v_add_f32 v23, v23, v27
    v_cvt_pk_bf16_f32 v24, v20, v21
    v_cvt_pk_bf16_f32 v25, v22, v23
    v_lshlrev_b32 v20, 16, v24
    v_and_b32 v21, 0xffff0000, v24
    v_lshlrev_b32 v22, 16, v25
    v_and_b32 v23, 0xffff0000, v25
    s_mov_b32 s58, 0xbfb8aa3b
    v_mul_f32 v24, s58, v20
    v_mul_f32 v25, s58, v21
    v_mul_f32 v26, s58, v22
    v_mul_f32 v27, s58, v23
    v_exp_f32 v24, v24
    v_exp_f32 v25, v25
    v_exp_f32 v26, v26
    v_exp_f32 v27, v27
    v_add_f32 v24, 1.0, v24
    v_add_f32 v25, 1.0, v25
    v_add_f32 v26, 1.0, v26
    v_add_f32 v27, 1.0, v27
    v_rcp_f32 v24, v24
    v_rcp_f32 v25, v25
    v_rcp_f32 v26, v26
    v_rcp_f32 v27, v27
    v_mul_f32 v24, v24, v20
    v_mul_f32 v25, v25, v21
    v_mul_f32 v26, v26, v22
    v_mul_f32 v27, v27, v23
    v_cvt_pk_bf16_f32 v52, v24, v25
    v_cvt_pk_bf16_f32 v53, v26, v27
    v_lshlrev_b32 v54, 16, v52
    v_and_b32 v55, 0xffff0000, v52
    v_lshlrev_b32 v56, 16, v53
    v_and_b32 v57, 0xffff0000, v53
    v_lshlrev_b32 v40, 16, v50
    v_and_b32 v41, 0xffff0000, v50
    v_lshlrev_b32 v42, 16, v51
    v_and_b32 v43, 0xffff0000, v51
    s_mov_b32 s53, 0
L_FN_P2:
    buffer_load_dwordx4 v[20:23], v63, s[32:35], s49 offen sc1
    buffer_load_dwordx4 v[24:27], v63, s[32:35], s55 offen sc1
    buffer_load_dwordx4 v[28:31], v63, s[32:35], s56 offen sc1
    buffer_load_dwordx4 v[32:35], v63, s[32:35], s57 offen sc1
    s_waitcnt vmcnt(4)
    v_max3_u32 v36, v66, v67, v68
    v_max3_u32 v37, v69, v70, v71
    v_max3_u32 v38, v72, v73, v74
    v_max3_u32 v39, v75, v76, v77
    v_max3_u32 v36, v36, v78, v79
    v_max3_u32 v37, v37, v80, v81
    v_max3_u32 v36, v36, v38, v39
    v_max_u32 v36, v36, v37
    v_cmp_eq_u32 vcc, -1, v36
    s_cbranch_vccz L_FN_OKB
    buffer_load_dwordx4 v[66:69], v63, s[32:35], s49 offen sc1
    buffer_load_dwordx4 v[70:73], v63, s[32:35], s55 offen sc1
    buffer_load_dwordx4 v[74:77], v63, s[32:35], s56 offen sc1
    buffer_load_dwordx4 v[78:81], v63, s[32:35], s57 offen sc1
    s_waitcnt vmcnt(4)
    v_max3_u32 v36, v20, v21, v22
    v_max3_u32 v37, v23, v24, v25
    v_max3_u32 v38, v26, v27, v28
    v_max3_u32 v39, v29, v30, v31
    v_max3_u32 v36, v36, v32, v33
    v_max3_u32 v37, v37, v34, v35
    v_max3_u32 v36, v36, v38, v39
    v_max_u32 v36, v36, v37
    v_cmp_eq_u32 vcc, -1, v36
    s_add_u32 s53, s53, 1
    s_cmp_gt_u32 s53, 20000
    s_cbranch_scc1 L_FN_OKA
    s_cbranch_vccnz L_FN_P2
    s_branch L_FN_OKA
L_FN_OKB:
    v_add_f32 v84, v66, v70
    v_add_f32 v88, v74, v78
    v_add_f32 v85, v67, v71
    v_add_f32 v89, v75, v79
    v_add_f32 v86, v68, v72
    v_add_f32 v90, v76, v80
    v_add_f32 v87, v69, v73
    v_add_f32 v91, v77, v81
    s_branch L_FN_OK2
L_FN_OKA:
    v_add_f32 v84, v20, v24
    v_add_f32 v88, v28, v32
    v_add_f32 v85, v21, v25
    v_add_f32 v89, v29, v33
    v_add_f32 v86, v22, v26
    v_add_f32 v90, v30, v34
    v_add_f32 v87, v23, v27
    v_add_f32 v91, v31, v35
L_FN_OK2:
    v_add_f32 v84, v84, v88
    v_add_f32 v85, v85, v89
    v_add_f32 v86, v86, v90
    v_add_f32 v87, v87, v91
    v_add_f32_dpp v84, v84, v84 row_ror:8 row_mask:0xf bank_mask:0xf
    v_add_f32_dpp v85, v85, v85 row_ror:8 row_mask:0xf bank_mask:0xf
    v_add_f32_dpp v86, v86, v86 row_ror:8 row_mask:0xf bank_mask:0xf
    v_add_f32_dpp v87, v87, v87 row_ror:8 row_mask:0xf bank_mask:0xf
    v_mov_b32 v88, v84
    v_mov_b32 v89, v85
    v_mov_b32 v90, v86
    v_mov_b32 v91, v87
    v_permlane16_swap_b32 v88, v84
    v_permlane16_swap_b32 v89, v85
    v_permlane16_swap_b32 v90, v86
    v_permlane16_swap_b32 v91, v87
    v_add_f32 v84, v84, v88
    v_add_f32 v85, v85, v89
    v_add_f32 v86, v86, v90
    v_add_f32 v87, v87, v91
    v_mov_b32 v88, v84
    v_mov_b32 v89, v85
    v_mov_b32 v90, v86
    v_mov_b32 v91, v87
    v_permlane32_swap_b32 v88, v84
    v_permlane32_swap_b32 v89, v85
    v_permlane32_swap_b32 v90, v86
    v_permlane32_swap_b32 v91, v87
    v_add_f32 v84, v84, v88
    v_add_f32 v85, v85, v89
    v_add_f32 v86, v86, v90
    v_add_f32 v87, v87, v91
    v_cvt_pk_bf16_f32 v88, v84, v85
    v_cvt_pk_bf16_f32 v89, v86, v87
    v_lshlrev_b32 v84, 16, v88
    v_and_b32 v85, 0xffff0000, v88
    v_lshlrev_b32 v86, 16, v89
    v_and_b32 v87, 0xffff0000, v89
    v_mul_f32 v84, v84, v54
    v_mul_f32 v85, v85, v55
    v_mul_f32 v86, v86, v56
    v_mul_f32 v87, v87, v57
    v_cvt_pk_bf16_f32 v88, v84, v85
    v_cvt_pk_bf16_f32 v89, v86, v87
    v_lshlrev_b32 v84, 16, v88
    v_and_b32 v85, 0xffff0000, v88
    v_lshlrev_b32 v86, 16, v89
    v_and_b32 v87, 0xffff0000, v89
    v_add_f32 v84, v84, v40
    v_add_f32 v85, v85, v41
    v_add_f32 v86, v86, v42
    v_add_f32 v87, v87, v43
    v_cvt_pk_bf16_f32 v88, v84, v85
    v_cvt_pk_bf16_f32 v89, v86, v87
    s_mov_b64 exec, 0xff
    buffer_store_dwordx2 v[88:89], v62, s[40:43], s48 offen
    s_mov_b64 exec, -1
L_SV_EXIT:
L_END:
    s_endpgm
.p2align 6
L_CODE_END:
    s_endpgm
.fill 289, 4, 0xBF810000
.section .rodata,"a"
.p2align 6
.amdhsa_kernel recurrent_scan__sliding_block_cached__geglu_ffn__decode_kernel
  .amdhsa_next_free_vgpr 168
  .amdhsa_next_free_sgpr 102
  .amdhsa_accum_offset 100
  .amdhsa_group_segment_fixed_size 0
  .amdhsa_kernarg_size 96
  .amdhsa_user_sgpr_count 2
  .amdhsa_user_sgpr_kernarg_segment_ptr 1
  .amdhsa_system_sgpr_workgroup_id_x 1
.end_amdhsa_kernel
```
